```python
import torch

def _softmax(x, axis=-1):
    return torch.softmax(x, dim=axis)
def _gelu(x):
    return torch.nn.functional.gelu(x, approximate="tanh")
def _silu(x):
    return torch.nn.functional.silu(x)
def _sigmoid(x):
    return torch.sigmoid(x)
def _layernorm(x, axis=-1, eps=1e-5):
    m = x.mean(dim=axis, keepdim=True)
    v = x.var(dim=axis, keepdim=True, unbiased=False)
    return (x - m) / torch.sqrt(v + eps)
def _scatter_add(tgt, idx, src, axis=0):
    return tgt.clone().index_add_(axis, idx, src)
def _segment_sum(src, seg, n):
    out = torch.zeros((n,) + src.shape[1:], dtype=src.dtype)
    return out.index_add_(0, seg, src)
def _pad(x, pw):
    flat = tuple(v for pair in reversed(pw) for v in pair)
    return torch.nn.functional.pad(x, flat)

kernel_name = 'standalone__grouped_kv_mqa__prompt'

def setup_inputs():

    _w = (lambda a: (lambda t: t.to(torch.bfloat16) if t.is_floating_point() else t)(torch.as_tensor(a)))
    B, S, D, H = 1, 2048, 576, 32
    Dh = D // H
    return {
        "x": _w((lambda *s: torch.randn(*s, dtype=torch.bfloat16) * 0.05)(B, S, D)),
        "wq": _w((lambda *s: torch.randn(*s, dtype=torch.bfloat16) * 0.8)(D, H * Dh)),
        "wk": _w((lambda *s: torch.randn(*s, dtype=torch.bfloat16) * 0.8)(D, Dh)),
        "wv": _w((lambda *s: torch.randn(*s, dtype=torch.bfloat16) * 0.05)(D, Dh)),
        "wo": _w((lambda *s: torch.randn(*s, dtype=torch.bfloat16) * 0.05)(H * Dh, D)),
    }

def reference(x, wq, wk, wv, wo):
    B, S, D = x.shape
    H = 32
    Dh = D // H
    q = (lambda x, *d: x.permute(*d))((x @ wq).reshape(B, S, H, Dh), 0, 2, 1, 3)
    k = x @ wk
    v = x @ wv
    scores = torch.einsum("bhqd,bkd->bhqk", q, k) * (Dh ** -0.5)
    p = _softmax(scores, axis=-1)
    o = torch.einsum("bhqk,bkd->bhqd", p, v)
    return (lambda x, *d: x.permute(*d))(o, 0, 2, 1, 3).reshape(B, S, H * Dh) @ wo
```

```asm
; @launch grid=(256,1,1) block=(512,1,1) lds=163840
.amdgcn_target "amdgcn-amd-amdhsa--gfx950"
.text
.globl standalone__grouped_kv_mqa__prompt_kernel
.p2align 8
.type standalone__grouped_kv_mqa__prompt_kernel,@function
standalone__grouped_kv_mqa__prompt_kernel:
    s_cmp_ge_u32 s2, 256
    s_cbranch_scc1 L_end
    s_load_dwordx16 s[4:19], s[0:1], 0
    v_and_b32 v1, 63, v0
    v_lshrrev_b32 v2, 6, v0
    s_and_b32 s53, s2, 7
    v_readfirstlane_b32 s52, v2
    s_lshr_b32 s60, s2, 6
    s_lshl_b32 s59, s60, 3
    s_cmp_lg_u32 s52, 7
    s_cbranch_scc1 L_nocpf
    s_getpc_b64 s[78:79]
L_pc:
    s_sub_u32 s78, s78, L_pc-standalone__grouped_kv_mqa__prompt_kernel
    s_subb_u32 s79, s79, 0
    v_lshlrev_b32 v4, 7, v1
    v_mov_b32 v5, s79
    v_add_co_u32 v4, vcc, s78, v4
    s_nop 1
    v_addc_co_u32 v5, vcc, 0, v5, vcc
    v_cmp_gt_u32 vcc, (L_codeend-standalone__grouped_kv_mqa__prompt_kernel-0+127)/128, v1
    s_and_b64 exec, exec, vcc
    global_load_dword v16, v[4:5], off
    s_mov_b64 exec, -1
    v_add_co_u32 v4, vcc, 0x2000, v4
    s_nop 1
    v_addc_co_u32 v5, vcc, 0, v5, vcc
    v_cmp_gt_u32 vcc, (L_codeend-standalone__grouped_kv_mqa__prompt_kernel-8192+127)/128, v1
    s_and_b64 exec, exec, vcc
    global_load_dword v17, v[4:5], off
    s_mov_b64 exec, -1
    v_add_co_u32 v4, vcc, 0x2000, v4
    s_nop 1
    v_addc_co_u32 v5, vcc, 0, v5, vcc
    v_cmp_gt_u32 vcc, (L_codeend-standalone__grouped_kv_mqa__prompt_kernel-16384+127)/128, v1
    s_and_b64 exec, exec, vcc
    global_load_dword v18, v[4:5], off
    s_mov_b64 exec, -1
L_nocpf:
    s_add_u32 s53, s53, s59
    s_lshr_b32 s54, s2, 3
    s_and_b32 s54, s54, 7
    s_and_b32 s55, s54, 3
    s_lshr_b32 s56, s54, 2
    s_add_u32 s60, s60, s54
    s_mul_i32 s61, s60, 11
    s_lshr_b32 s61, s61, 5
    s_mul_i32 s61, s61, 3
    s_sub_u32 s60, s60, s61
    s_mul_i32 s96, s60, 221184
    s_mul_i32 s99, s60, 384
    s_add_u32 s60, s60, 1
    s_cmp_eq_u32 s60, 3
    s_cselect_b32 s60, 0, s60
    s_mul_i32 s97, s60, 221184
    s_mul_i32 s100, s60, 384
    s_add_u32 s60, s60, 1
    s_cmp_eq_u32 s60, 3
    s_cselect_b32 s60, 0, s60
    s_mul_i32 s98, s60, 221184
    s_mul_i32 s101, s60, 384
    v_lshrrev_b32 v4, 3, v1
    v_lshrrev_b32 v5, 4, v1
    v_and_b32 v6, 7, v1
    v_xor_b32 v5, v5, v6
    v_lshlrev_b32 v5, 4, v5
    s_lshl_b32 s59, s53, 6
    v_add_u32 v4, s59, v4
    v_mul_u32_u24 v3, 1152, v4
    v_add_u32 v3, v3, v5
    v_lshlrev_b32 v15, 4, v1
    s_lshr_b32 s57, s52, 1
    s_and_b32 s58, s52, 1
    s_sub_u32 s92, s52, 1
    s_cmp_eq_u32 s52, 0
    s_cbranch_scc0 L_bulk
L_w0:
    s_setprio 3
    s_memrealtime s[78:79]
    v_mul_u32_u24 v4, 43, v1
    v_lshrrev_b32 v4, 7, v4
    v_mul_u32_u24 v5, 3, v4
    v_sub_u32 v5, v1, v5
    v_mul_u32_u24 v9, 36, v4
    v_lshl_add_u32 v9, v5, 4, v9
    v_xor_b32 v8, 64, v3
    s_lshl_b32 s70, s55, 11
    s_add_u32 s70, s70, 87552
    s_mul_i32 s71, s55, 18432
    s_add_u32 s60, s71, 9216
    v_mov_b32 v6, 0
    s_waitcnt lgkmcnt(0)
    s_cmp_eq_u32 s56, 1
    s_cselect_b32 s28, s10, s8
    s_cselect_b32 s29, s11, s9
    s_mov_b32 s30, 20736
    s_mov_b32 s31, 0x00020000
    s_mov_b32 s20, s4
    s_mov_b32 s21, s5
    s_mov_b32 s22, 2359296
    s_mov_b32 s23, 0x00020000
    s_mov_b32 s48, s16
    s_mov_b32 s49, s17
    s_mov_b32 s50, 256
    s_mov_b32 s51, 0x00020000
    s_cmp_lg_u32 s2, 0
    s_cbranch_scc1 L_nononce
    s_or_b32 s78, s78, 1
    v_mov_b32 v4, s78
    v_mov_b32 v5, s79
    s_mov_b64 exec, 1
    buffer_store_dwordx2 v[4:5], v6, s[48:51], 0 offen sc1
    s_mov_b64 exec, -1
L_nononce:
    s_mov_b32 m0, 29184
    s_mov_b32 s59, 0
    buffer_load_dwordx4 v9, s[28:31], s59 offen lds
    s_mov_b32 m0, 30192
    s_mov_b32 s59, 756
    buffer_load_dwordx4 v9, s[28:31], s59 offen lds
    s_mov_b32 m0, 31200
    s_mov_b32 s59, 1512
    buffer_load_dwordx4 v9, s[28:31], s59 offen lds
    s_mov_b32 m0, 32208
    s_mov_b32 s59, 2268
    buffer_load_dwordx4 v9, s[28:31], s59 offen lds
    s_mov_b32 m0, 33216
    s_mov_b32 s59, 3024
    buffer_load_dwordx4 v9, s[28:31], s59 offen lds
    s_mov_b32 m0, 34224
    s_mov_b32 s59, 3780
    buffer_load_dwordx4 v9, s[28:31], s59 offen lds
    s_mov_b32 m0, 35232
    s_mov_b32 s59, 4536
    buffer_load_dwordx4 v9, s[28:31], s59 offen lds
    s_mov_b32 m0, 36240
    s_mov_b32 s59, 5292
    buffer_load_dwordx4 v9, s[28:31], s59 offen lds
    s_mov_b32 m0, 37248
    s_mov_b32 s59, 6048
    buffer_load_dwordx4 v9, s[28:31], s59 offen lds
    s_mov_b32 m0, 38256
    s_mov_b32 s59, 6804
    buffer_load_dwordx4 v9, s[28:31], s59 offen lds
    s_mov_b32 m0, 39264
    s_mov_b32 s59, 7560
    buffer_load_dwordx4 v9, s[28:31], s59 offen lds
    s_mov_b32 m0, 40272
    s_mov_b32 s59, 8316
    buffer_load_dwordx4 v9, s[28:31], s59 offen lds
    s_mov_b32 m0, 41280
    s_mov_b32 s59, 9072
    buffer_load_dwordx4 v9, s[28:31], s59 offen lds
    s_mov_b32 m0, 42288
    s_mov_b32 s59, 9828
    buffer_load_dwordx4 v9, s[28:31], s59 offen lds
    s_add_u32 m0, s70, 65536
    s_add_u32 s59, s71, s99
    buffer_load_dwordx4 v3, s[20:23], s59 offen offset:0 lds
    s_add_u32 m0, s70, 66560
    s_add_u32 s59, s60, s99
    buffer_load_dwordx4 v8, s[20:23], s59 offen offset:0 lds
    s_add_u32 m0, s70, -128
    s_add_u32 s59, s71, s99
    buffer_load_dwordx4 v3, s[20:23], s59 offen offset:128 lds
    s_add_u32 m0, s70, 896
    s_add_u32 s59, s60, s99
    buffer_load_dwordx4 v8, s[20:23], s59 offen offset:128 lds
    s_add_u32 m0, s70, 7936
    s_add_u32 s59, s71, s99
    buffer_load_dwordx4 v3, s[20:23], s59 offen offset:256 lds
    s_add_u32 m0, s70, 8960
    s_add_u32 s59, s60, s99
    buffer_load_dwordx4 v8, s[20:23], s59 offen offset:256 lds
    s_mov_b32 m0, 43296
    s_mov_b32 s59, 10584
    buffer_load_dwordx4 v9, s[28:31], s59 offen lds
    s_mov_b32 m0, 44304
    s_mov_b32 s59, 11340
    buffer_load_dwordx4 v9, s[28:31], s59 offen lds
    s_mov_b32 m0, 45312
    s_mov_b32 s59, 12096
    buffer_load_dwordx4 v9, s[28:31], s59 offen lds
    s_mov_b32 m0, 46320
    s_mov_b32 s59, 12852
    buffer_load_dwordx4 v9, s[28:31], s59 offen lds
    s_mov_b32 m0, 47328
    s_mov_b32 s59, 13608
    buffer_load_dwordx4 v9, s[28:31], s59 offen lds
    s_mov_b32 m0, 48336
    s_mov_b32 s59, 14364
    buffer_load_dwordx4 v9, s[28:31], s59 offen lds
    s_mov_b32 m0, 49344
    s_mov_b32 s59, 15120
    buffer_load_dwordx4 v9, s[28:31], s59 offen lds
    s_mov_b32 m0, 50352
    s_mov_b32 s59, 15876
    buffer_load_dwordx4 v9, s[28:31], s59 offen lds
    s_mov_b32 m0, 51360
    s_mov_b32 s59, 16632
    buffer_load_dwordx4 v9, s[28:31], s59 offen lds
    s_mov_b32 m0, 52368
    s_mov_b32 s59, 17388
    buffer_load_dwordx4 v9, s[28:31], s59 offen lds
    s_mov_b32 m0, 53376
    s_mov_b32 s59, 18144
    buffer_load_dwordx4 v9, s[28:31], s59 offen lds
    s_mov_b32 m0, 54384
    s_mov_b32 s59, 18900
    buffer_load_dwordx4 v9, s[28:31], s59 offen lds
    s_mov_b32 m0, 55392
    s_mov_b32 s59, 19656
    buffer_load_dwordx4 v9, s[28:31], s59 offen lds
    s_mov_b32 m0, 56400
    s_mov_b32 s59, 20412
    buffer_load_dwordx4 v9, s[28:31], s59 offen lds
    s_add_u32 m0, s70, 16384
    s_add_u32 s59, s71, s100
    buffer_load_dwordx4 v3, s[20:23], s59 offen offset:0 lds
    s_add_u32 m0, s70, 17408
    s_add_u32 s59, s60, s100
    buffer_load_dwordx4 v8, s[20:23], s59 offen offset:0 lds
    s_add_u32 m0, s70, 24448
    s_add_u32 s59, s71, s100
    buffer_load_dwordx4 v3, s[20:23], s59 offen offset:128 lds
    s_add_u32 m0, s70, 25472
    s_add_u32 s59, s60, s100
    buffer_load_dwordx4 v8, s[20:23], s59 offen offset:128 lds
    s_add_u32 m0, s70, 32512
    s_add_u32 s59, s71, s100
    buffer_load_dwordx4 v3, s[20:23], s59 offen offset:256 lds
    s_add_u32 m0, s70, 33536
    s_add_u32 s59, s60, s100
    buffer_load_dwordx4 v8, s[20:23], s59 offen offset:256 lds
    s_add_u32 m0, s70, 40960
    s_add_u32 s59, s71, s101
    buffer_load_dwordx4 v3, s[20:23], s59 offen offset:0 lds
    s_add_u32 m0, s70, 41984
    s_add_u32 s59, s60, s101
    buffer_load_dwordx4 v8, s[20:23], s59 offen offset:0 lds
    s_add_u32 m0, s70, 49024
    s_add_u32 s59, s71, s101
    buffer_load_dwordx4 v3, s[20:23], s59 offen offset:128 lds
    s_add_u32 m0, s70, 50048
    s_add_u32 s59, s60, s101
    buffer_load_dwordx4 v8, s[20:23], s59 offen offset:128 lds
    s_add_u32 m0, s70, 57088
    s_add_u32 s59, s71, s101
    buffer_load_dwordx4 v3, s[20:23], s59 offen offset:256 lds
    s_add_u32 m0, s70, 58112
    s_add_u32 s59, s60, s101
    buffer_load_dwordx4 v8, s[20:23], s59 offen offset:256 lds
    buffer_load_dwordx2 v[118:119], v6, s[48:51], 0 offen sc1
    s_mov_b32 s24, s6
    s_mov_b32 s25, s7
    s_mov_b32 s26, 663552
    s_mov_b32 s27, 0x00020000
    s_mov_b32 s32, s18
    s_mov_b32 s33, s19
    s_mov_b32 s34, 262144
    s_mov_b32 s35, 0x00020000
    s_add_u32 s36, s18, 262144
    s_addc_u32 s37, s19, 0
    s_mov_b32 s38, 2359296
    s_mov_b32 s39, 0x00020000
    s_mov_b32 s40, s12
    s_mov_b32 s41, s13
    s_mov_b32 s42, 663552
    s_mov_b32 s43, 0x00020000
    s_mov_b32 s44, s14
    s_mov_b32 s45, s15
    s_mov_b32 s46, 2359296
    s_mov_b32 s47, 0x00020000
    v_mul_u32_u24 v4, 27, v1
    v_lshrrev_b32 v4, 9, v4
    v_mul_u32_u24 v5, 19, v4
    v_sub_u32 v5, v1, v5
    v_min_u32 v5, 17, v5
    v_cmp_le_u32 vcc, 9, v5
    v_lshlrev_b32 v4, 1, v4
    v_subrev_u32 v6, 9, v5
    v_cndmask_b32 v5, v5, v6, vcc
    v_addc_co_u32 v4, vcc, 0, v4, vcc
    v_mul_u32_u24 v7, 1152, v4
    v_lshl_add_u32 v7, v5, 4, v7
    s_mul_i32 s90, s54, 144
    v_add_u32 v7, s90, v7
    v_and_b32 v4, 15, v1
    s_lshl_b32 s59, s55, 4
    v_add_u32 v4, s59, v4
    v_lshrrev_b32 v5, 1, v4
    v_and_b32 v5, 7, v5
    v_lshrrev_b32 v6, 4, v1
    v_xor_b32 v8, v6, v5
    v_lshlrev_b32 v8, 4, v8
    v_lshl_add_u32 v10, v4, 7, v8
    v_add_u32 v10, 87552, v10
    v_xor_b32 v11, 64, v10
    v_bfe_u32 v4, v1, 2, 2
    v_lshl_add_u32 v4, v6, 3, v4
    v_mul_u32_u24 v4, 48, v4
    v_and_b32 v5, 3, v1
    v_lshl_add_u32 v12, v5, 3, v4
    v_add_u32 v12, 29184, v12
    s_mul_i32 s59, s99, 24
    v_add_u32 v121, s59, v12
    s_mul_i32 s59, s100, 24
    v_add_u32 v122, s59, v12
    s_mul_i32 s59, s101, 24
    v_add_u32 v123, s59, v12
    v_add_u32 v13, 0x10000, v10
    v_add_u32 v14, 0x10000, v11
    s_lshl_b32 s59, s53, 1
    s_lshr_b32 s60, s55, 1
    s_add_u32 s59, s59, s60
    s_mul_i32 s59, s59, 2368
    s_and_b32 s60, s55, 1
    v_and_b32 v4, 15, v1
    v_lshrrev_b32 v5, 5, v1
    v_bfe_u32 v6, v1, 4, 1
    s_cmp_eq_u32 s56, 1
    s_cbranch_scc1 L_vproj
    s_lshl_b32 s61, s60, 8
    s_add_u32 s61, s61, s59
    s_lshl_b32 s63, s60, 6
    s_add_u32 s63, s63, s59
    v_lshlrev_b32 v5, 9, v5
    v_lshl_add_u32 v5, v4, 4, v5
    v_lshl_add_u32 v16, v6, 3, v5
    v_lshlrev_b32 v17, 2, v4
    s_waitcnt vmcnt(13)
    ds_read_b128 v[32:35], v13
    ds_read_b64_tr_b16 v[36:37], v121 offset:0
    ds_read_b64_tr_b16 v[38:39], v121 offset:192
    ds_read_b64_tr_b16 v[40:41], v121 offset:32
    ds_read_b64_tr_b16 v[42:43], v121 offset:224
    ds_read_b128 v[44:47], v14
    ds_read_b64_tr_b16 v[48:49], v121 offset:1536
    ds_read_b64_tr_b16 v[50:51], v121 offset:1728
    ds_read_b64_tr_b16 v[52:53], v121 offset:1568
    ds_read_b64_tr_b16 v[54:55], v121 offset:1760
    ds_read_b128 v[56:59], v10 offset:0
    ds_read_b64_tr_b16 v[60:61], v121 offset:3072
    ds_read_b64_tr_b16 v[62:63], v121 offset:3264
    ds_read_b64_tr_b16 v[64:65], v121 offset:3104
    ds_read_b64_tr_b16 v[66:67], v121 offset:3296
    s_waitcnt lgkmcnt(10)
    v_mfma_f32_16x16x32_bf16 v[20:23], v[36:39], v[32:35], 0
    v_mfma_f32_16x16x32_bf16 v[24:27], v[40:43], v[32:35], 0
    ds_read_b128 v[32:35], v11 offset:0
    ds_read_b64_tr_b16 v[36:37], v121 offset:4608
    ds_read_b64_tr_b16 v[38:39], v121 offset:4800
    ds_read_b64_tr_b16 v[40:41], v121 offset:4640
    ds_read_b64_tr_b16 v[42:43], v121 offset:4832
    s_waitcnt lgkmcnt(10)
    v_mfma_f32_16x16x32_bf16 v[20:23], v[48:51], v[44:47], v[20:23]
    v_mfma_f32_16x16x32_bf16 v[24:27], v[52:55], v[44:47], v[24:27]
    ds_read_b128 v[44:47], v10 offset:8192
    ds_read_b64_tr_b16 v[48:49], v121 offset:6144
    ds_read_b64_tr_b16 v[50:51], v121 offset:6336
    ds_read_b64_tr_b16 v[52:53], v121 offset:6176
    ds_read_b64_tr_b16 v[54:55], v121 offset:6368
    s_waitcnt lgkmcnt(10)
    v_mfma_f32_16x16x32_bf16 v[20:23], v[60:63], v[56:59], v[20:23]
    v_mfma_f32_16x16x32_bf16 v[24:27], v[64:67], v[56:59], v[24:27]
    ds_read_b128 v[56:59], v11 offset:8192
    ds_read_b64_tr_b16 v[60:61], v121 offset:7680
    ds_read_b64_tr_b16 v[62:63], v121 offset:7872
    ds_read_b64_tr_b16 v[64:65], v121 offset:7712
    ds_read_b64_tr_b16 v[66:67], v121 offset:7904
    s_waitcnt lgkmcnt(10)
    v_mfma_f32_16x16x32_bf16 v[20:23], v[36:39], v[32:35], v[20:23]
    v_mfma_f32_16x16x32_bf16 v[24:27], v[40:43], v[32:35], v[24:27]
    s_waitcnt vmcnt(11)
    ds_read_b128 v[32:35], v10 offset:16384
    ds_read_b64_tr_b16 v[36:37], v122 offset:0
    ds_read_b64_tr_b16 v[38:39], v122 offset:192
    ds_read_b64_tr_b16 v[40:41], v122 offset:32
    ds_read_b64_tr_b16 v[42:43], v122 offset:224
    s_waitcnt lgkmcnt(10)
    v_mfma_f32_16x16x32_bf16 v[20:23], v[48:51], v[44:47], v[20:23]
    v_mfma_f32_16x16x32_bf16 v[24:27], v[52:55], v[44:47], v[24:27]
    ds_read_b128 v[44:47], v11 offset:16384
    ds_read_b64_tr_b16 v[48:49], v122 offset:1536
    ds_read_b64_tr_b16 v[50:51], v122 offset:1728
    ds_read_b64_tr_b16 v[52:53], v122 offset:1568
    ds_read_b64_tr_b16 v[54:55], v122 offset:1760
    s_waitcnt lgkmcnt(10)
    v_mfma_f32_16x16x32_bf16 v[20:23], v[60:63], v[56:59], v[20:23]
    v_mfma_f32_16x16x32_bf16 v[24:27], v[64:67], v[56:59], v[24:27]
    s_waitcnt vmcnt(9)
    ds_read_b128 v[56:59], v10 offset:24576
    ds_read_b64_tr_b16 v[60:61], v122 offset:3072
    ds_read_b64_tr_b16 v[62:63], v122 offset:3264
    ds_read_b64_tr_b16 v[64:65], v122 offset:3104
    ds_read_b64_tr_b16 v[66:67], v122 offset:3296
    s_waitcnt lgkmcnt(10)
    v_mfma_f32_16x16x32_bf16 v[20:23], v[36:39], v[32:35], v[20:23]
    v_mfma_f32_16x16x32_bf16 v[24:27], v[40:43], v[32:35], v[24:27]
    ds_read_b128 v[32:35], v11 offset:24576
    ds_read_b64_tr_b16 v[36:37], v122 offset:4608
    ds_read_b64_tr_b16 v[38:39], v122 offset:4800
    ds_read_b64_tr_b16 v[40:41], v122 offset:4640
    ds_read_b64_tr_b16 v[42:43], v122 offset:4832
    s_waitcnt lgkmcnt(10)
    v_mfma_f32_16x16x32_bf16 v[20:23], v[48:51], v[44:47], v[20:23]
    v_mfma_f32_16x16x32_bf16 v[24:27], v[52:55], v[44:47], v[24:27]
    s_waitcnt vmcnt(7)
    ds_read_b128 v[44:47], v10 offset:32768
    ds_read_b64_tr_b16 v[48:49], v122 offset:6144
    ds_read_b64_tr_b16 v[50:51], v122 offset:6336
    ds_read_b64_tr_b16 v[52:53], v122 offset:6176
    ds_read_b64_tr_b16 v[54:55], v122 offset:6368
    s_waitcnt lgkmcnt(10)
    v_mfma_f32_16x16x32_bf16 v[20:23], v[60:63], v[56:59], v[20:23]
    v_mfma_f32_16x16x32_bf16 v[24:27], v[64:67], v[56:59], v[24:27]
    ds_read_b128 v[56:59], v11 offset:32768
    ds_read_b64_tr_b16 v[60:61], v122 offset:7680
    ds_read_b64_tr_b16 v[62:63], v122 offset:7872
    ds_read_b64_tr_b16 v[64:65], v122 offset:7712
    ds_read_b64_tr_b16 v[66:67], v122 offset:7904
    s_waitcnt lgkmcnt(10)
    v_mfma_f32_16x16x32_bf16 v[20:23], v[36:39], v[32:35], v[20:23]
    v_mfma_f32_16x16x32_bf16 v[24:27], v[40:43], v[32:35], v[24:27]
    s_waitcnt vmcnt(5)
    ds_read_b128 v[32:35], v10 offset:40960
    ds_read_b64_tr_b16 v[36:37], v123 offset:0
    ds_read_b64_tr_b16 v[38:39], v123 offset:192
    ds_read_b64_tr_b16 v[40:41], v123 offset:32
    ds_read_b64_tr_b16 v[42:43], v123 offset:224
    s_waitcnt lgkmcnt(10)
    v_mfma_f32_16x16x32_bf16 v[20:23], v[48:51], v[44:47], v[20:23]
    v_mfma_f32_16x16x32_bf16 v[24:27], v[52:55], v[44:47], v[24:27]
    ds_read_b128 v[44:47], v11 offset:40960
    ds_read_b64_tr_b16 v[48:49], v123 offset:1536
    ds_read_b64_tr_b16 v[50:51], v123 offset:1728
    ds_read_b64_tr_b16 v[52:53], v123 offset:1568
    ds_read_b64_tr_b16 v[54:55], v123 offset:1760
    s_waitcnt lgkmcnt(10)
    v_mfma_f32_16x16x32_bf16 v[20:23], v[60:63], v[56:59], v[20:23]
    v_mfma_f32_16x16x32_bf16 v[24:27], v[64:67], v[56:59], v[24:27]
    s_waitcnt vmcnt(3)
    ds_read_b128 v[56:59], v10 offset:49152
    ds_read_b64_tr_b16 v[60:61], v123 offset:3072
    ds_read_b64_tr_b16 v[62:63], v123 offset:3264
    ds_read_b64_tr_b16 v[64:65], v123 offset:3104
    ds_read_b64_tr_b16 v[66:67], v123 offset:3296
    s_waitcnt lgkmcnt(10)
    v_mfma_f32_16x16x32_bf16 v[20:23], v[36:39], v[32:35], v[20:23]
    v_mfma_f32_16x16x32_bf16 v[24:27], v[40:43], v[32:35], v[24:27]
    ds_read_b128 v[32:35], v11 offset:49152
    ds_read_b64_tr_b16 v[36:37], v123 offset:4608
    ds_read_b64_tr_b16 v[38:39], v123 offset:4800
    ds_read_b64_tr_b16 v[40:41], v123 offset:4640
    ds_read_b64_tr_b16 v[42:43], v123 offset:4832
    s_waitcnt lgkmcnt(10)
    v_mfma_f32_16x16x32_bf16 v[20:23], v[48:51], v[44:47], v[20:23]
    v_mfma_f32_16x16x32_bf16 v[24:27], v[52:55], v[44:47], v[24:27]
    s_waitcnt vmcnt(1)
    ds_read_b128 v[44:47], v10 offset:57344
    ds_read_b64_tr_b16 v[48:49], v123 offset:6144
    ds_read_b64_tr_b16 v[50:51], v123 offset:6336
    ds_read_b64_tr_b16 v[52:53], v123 offset:6176
    ds_read_b64_tr_b16 v[54:55], v123 offset:6368
    s_waitcnt lgkmcnt(10)
    v_mfma_f32_16x16x32_bf16 v[20:23], v[60:63], v[56:59], v[20:23]
    v_mfma_f32_16x16x32_bf16 v[24:27], v[64:67], v[56:59], v[24:27]
    ds_read_b128 v[56:59], v11 offset:57344
    ds_read_b64_tr_b16 v[60:61], v123 offset:7680
    ds_read_b64_tr_b16 v[62:63], v123 offset:7872
    ds_read_b64_tr_b16 v[64:65], v123 offset:7712
    ds_read_b64_tr_b16 v[66:67], v123 offset:7904
    s_waitcnt lgkmcnt(10)
    v_mfma_f32_16x16x32_bf16 v[20:23], v[36:39], v[32:35], v[20:23]
    v_mfma_f32_16x16x32_bf16 v[24:27], v[40:43], v[32:35], v[24:27]
    s_waitcnt lgkmcnt(5)
    v_mfma_f32_16x16x32_bf16 v[20:23], v[48:51], v[44:47], v[20:23]
    v_mfma_f32_16x16x32_bf16 v[24:27], v[52:55], v[44:47], v[24:27]
    s_waitcnt lgkmcnt(0)
    v_mfma_f32_16x16x32_bf16 v[20:23], v[60:63], v[56:59], v[20:23]
    v_mfma_f32_16x16x32_bf16 v[24:27], v[64:67], v[56:59], v[24:27]
    s_nop 6
    v_cvt_pk_bf16_f32 v28, v20, v21
    v_cvt_pk_bf16_f32 v29, v22, v23
    v_cvt_pk_bf16_f32 v30, v24, v25
    buffer_store_dwordx2 v[28:29], v16, s[32:35], s61 offen sc1
    s_mov_b64 exec, 0xffff
    buffer_store_dword v30, v17, s[32:35], s63 offen offset:2240 sc1
    s_mov_b64 exec, -1
    s_branch L_setup
L_vproj:
    s_mul_i32 s61, s60, 608
    s_add_u32 s61, s61, s59
    v_mul_u32_u24 v5, 304, v5
    v_lshl_add_u32 v5, v4, 4, v5
    v_lshl_add_u32 v16, v6, 3, v5
    v_cmp_eq_u32 vcc, 2, v4
    v_cmp_gt_u32 s[76:77], 3, v4
    v_mov_b32 v2, 0x3f803f80
    s_waitcnt vmcnt(13)
    ds_read_b128 v[32:35], v13
    ds_read_b64_tr_b16 v[36:37], v121 offset:0
    ds_read_b64_tr_b16 v[38:39], v121 offset:192
    ds_read_b64_tr_b16 v[40:41], v121 offset:32
    ds_read_b64_tr_b16 v[42:43], v121 offset:224
    ds_read_b128 v[44:47], v14
    ds_read_b64_tr_b16 v[48:49], v121 offset:1536
    ds_read_b64_tr_b16 v[50:51], v121 offset:1728
    ds_read_b64_tr_b16 v[52:53], v121 offset:1568
    ds_read_b64_tr_b16 v[54:55], v121 offset:1760
    ds_read_b128 v[56:59], v10 offset:0
    ds_read_b64_tr_b16 v[60:61], v121 offset:3072
    ds_read_b64_tr_b16 v[62:63], v121 offset:3264
    ds_read_b64_tr_b16 v[64:65], v121 offset:3104
    ds_read_b64_tr_b16 v[66:67], v121 offset:3296
    s_waitcnt lgkmcnt(10)
    v_mfma_f32_16x16x32_bf16 v[20:23], v[32:35], v[36:39], 0
    v_mfma_f32_16x16x32_bf16 v[24:27], v[32:35], v[40:43], 0
    ds_read_b128 v[32:35], v11 offset:0
    ds_read_b64_tr_b16 v[36:37], v121 offset:4608
    ds_read_b64_tr_b16 v[38:39], v121 offset:4800
    ds_read_b64_tr_b16 v[40:41], v121 offset:4640
    ds_read_b64_tr_b16 v[42:43], v121 offset:4832
    s_waitcnt lgkmcnt(10)
    v_mfma_f32_16x16x32_bf16 v[20:23], v[44:47], v[48:51], v[20:23]
    v_mfma_f32_16x16x32_bf16 v[24:27], v[44:47], v[52:55], v[24:27]
    ds_read_b128 v[44:47], v10 offset:8192
    ds_read_b64_tr_b16 v[48:49], v121 offset:6144
    ds_read_b64_tr_b16 v[50:51], v121 offset:6336
    ds_read_b64_tr_b16 v[52:53], v121 offset:6176
    ds_read_b64_tr_b16 v[54:55], v121 offset:6368
    s_waitcnt lgkmcnt(10)
    v_mfma_f32_16x16x32_bf16 v[20:23], v[56:59], v[60:63], v[20:23]
    v_mfma_f32_16x16x32_bf16 v[24:27], v[56:59], v[64:67], v[24:27]
    ds_read_b128 v[56:59], v11 offset:8192
    ds_read_b64_tr_b16 v[60:61], v121 offset:7680
    ds_read_b64_tr_b16 v[62:63], v121 offset:7872
    ds_read_b64_tr_b16 v[64:65], v121 offset:7712
    ds_read_b64_tr_b16 v[66:67], v121 offset:7904
    s_waitcnt lgkmcnt(10)
    v_mfma_f32_16x16x32_bf16 v[20:23], v[32:35], v[36:39], v[20:23]
    v_mfma_f32_16x16x32_bf16 v[24:27], v[32:35], v[40:43], v[24:27]
    s_waitcnt vmcnt(11)
    ds_read_b128 v[32:35], v10 offset:16384
    ds_read_b64_tr_b16 v[36:37], v122 offset:0
    ds_read_b64_tr_b16 v[38:39], v122 offset:192
    ds_read_b64_tr_b16 v[40:41], v122 offset:32
    ds_read_b64_tr_b16 v[42:43], v122 offset:224
    s_waitcnt lgkmcnt(10)
    v_mfma_f32_16x16x32_bf16 v[20:23], v[44:47], v[48:51], v[20:23]
    v_mfma_f32_16x16x32_bf16 v[24:27], v[44:47], v[52:55], v[24:27]
    ds_read_b128 v[44:47], v11 offset:16384
    ds_read_b64_tr_b16 v[48:49], v122 offset:1536
    ds_read_b64_tr_b16 v[50:51], v122 offset:1728
    ds_read_b64_tr_b16 v[52:53], v122 offset:1568
    ds_read_b64_tr_b16 v[54:55], v122 offset:1760
    s_waitcnt lgkmcnt(10)
    v_mfma_f32_16x16x32_bf16 v[20:23], v[56:59], v[60:63], v[20:23]
    v_mfma_f32_16x16x32_bf16 v[24:27], v[56:59], v[64:67], v[24:27]
    s_waitcnt vmcnt(9)
    ds_read_b128 v[56:59], v10 offset:24576
    ds_read_b64_tr_b16 v[60:61], v122 offset:3072
    ds_read_b64_tr_b16 v[62:63], v122 offset:3264
    ds_read_b64_tr_b16 v[64:65], v122 offset:3104
    ds_read_b64_tr_b16 v[66:67], v122 offset:3296
    s_waitcnt lgkmcnt(10)
    v_mfma_f32_16x16x32_bf16 v[20:23], v[32:35], v[36:39], v[20:23]
    v_mfma_f32_16x16x32_bf16 v[24:27], v[32:35], v[40:43], v[24:27]
    ds_read_b128 v[32:35], v11 offset:24576
    ds_read_b64_tr_b16 v[36:37], v122 offset:4608
    ds_read_b64_tr_b16 v[38:39], v122 offset:4800
    ds_read_b64_tr_b16 v[40:41], v122 offset:4640
    ds_read_b64_tr_b16 v[42:43], v122 offset:4832
    s_waitcnt lgkmcnt(10)
    v_mfma_f32_16x16x32_bf16 v[20:23], v[44:47], v[48:51], v[20:23]
    v_mfma_f32_16x16x32_bf16 v[24:27], v[44:47], v[52:55], v[24:27]
    s_waitcnt vmcnt(7)
    ds_read_b128 v[44:47], v10 offset:32768
    ds_read_b64_tr_b16 v[48:49], v122 offset:6144
    ds_read_b64_tr_b16 v[50:51], v122 offset:6336
    ds_read_b64_tr_b16 v[52:53], v122 offset:6176
    ds_read_b64_tr_b16 v[54:55], v122 offset:6368
    s_waitcnt lgkmcnt(10)
    v_mfma_f32_16x16x32_bf16 v[20:23], v[56:59], v[60:63], v[20:23]
    v_mfma_f32_16x16x32_bf16 v[24:27], v[56:59], v[64:67], v[24:27]
    ds_read_b128 v[56:59], v11 offset:32768
    ds_read_b64_tr_b16 v[60:61], v122 offset:7680
    ds_read_b64_tr_b16 v[62:63], v122 offset:7872
    ds_read_b64_tr_b16 v[64:65], v122 offset:7712
    ds_read_b64_tr_b16 v[66:67], v122 offset:7904
    s_waitcnt lgkmcnt(10)
    v_mfma_f32_16x16x32_bf16 v[20:23], v[32:35], v[36:39], v[20:23]
    v_mfma_f32_16x16x32_bf16 v[24:27], v[32:35], v[40:43], v[24:27]
    s_waitcnt vmcnt(5)
    ds_read_b128 v[32:35], v10 offset:40960
    ds_read_b64_tr_b16 v[36:37], v123 offset:0
    ds_read_b64_tr_b16 v[38:39], v123 offset:192
    ds_read_b64_tr_b16 v[40:41], v123 offset:32
    ds_read_b64_tr_b16 v[42:43], v123 offset:224
    s_waitcnt lgkmcnt(10)
    v_mfma_f32_16x16x32_bf16 v[20:23], v[44:47], v[48:51], v[20:23]
    v_mfma_f32_16x16x32_bf16 v[24:27], v[44:47], v[52:55], v[24:27]
    ds_read_b128 v[44:47], v11 offset:40960
    ds_read_b64_tr_b16 v[48:49], v123 offset:1536
    ds_read_b64_tr_b16 v[50:51], v123 offset:1728
    ds_read_b64_tr_b16 v[52:53], v123 offset:1568
    ds_read_b64_tr_b16 v[54:55], v123 offset:1760
    s_waitcnt lgkmcnt(10)
    v_mfma_f32_16x16x32_bf16 v[20:23], v[56:59], v[60:63], v[20:23]
    v_mfma_f32_16x16x32_bf16 v[24:27], v[56:59], v[64:67], v[24:27]
    s_waitcnt vmcnt(3)
    ds_read_b128 v[56:59], v10 offset:49152
    ds_read_b64_tr_b16 v[60:61], v123 offset:3072
    ds_read_b64_tr_b16 v[62:63], v123 offset:3264
    ds_read_b64_tr_b16 v[64:65], v123 offset:3104
    ds_read_b64_tr_b16 v[66:67], v123 offset:3296
    s_waitcnt lgkmcnt(10)
    v_mfma_f32_16x16x32_bf16 v[20:23], v[32:35], v[36:39], v[20:23]
    v_mfma_f32_16x16x32_bf16 v[24:27], v[32:35], v[40:43], v[24:27]
    ds_read_b128 v[32:35], v11 offset:49152
    ds_read_b64_tr_b16 v[36:37], v123 offset:4608
    ds_read_b64_tr_b16 v[38:39], v123 offset:4800
    ds_read_b64_tr_b16 v[40:41], v123 offset:4640
    ds_read_b64_tr_b16 v[42:43], v123 offset:4832
    s_waitcnt lgkmcnt(10)
    v_mfma_f32_16x16x32_bf16 v[20:23], v[44:47], v[48:51], v[20:23]
    v_mfma_f32_16x16x32_bf16 v[24:27], v[44:47], v[52:55], v[24:27]
    s_waitcnt vmcnt(1)
    ds_read_b128 v[44:47], v10 offset:57344
    ds_read_b64_tr_b16 v[48:49], v123 offset:6144
    ds_read_b64_tr_b16 v[50:51], v123 offset:6336
    ds_read_b64_tr_b16 v[52:53], v123 offset:6176
    ds_read_b64_tr_b16 v[54:55], v123 offset:6368
    s_waitcnt lgkmcnt(10)
    v_mfma_f32_16x16x32_bf16 v[20:23], v[56:59], v[60:63], v[20:23]
    v_mfma_f32_16x16x32_bf16 v[24:27], v[56:59], v[64:67], v[24:27]
    ds_read_b128 v[56:59], v11 offset:57344
    ds_read_b64_tr_b16 v[60:61], v123 offset:7680
    ds_read_b64_tr_b16 v[62:63], v123 offset:7872
    ds_read_b64_tr_b16 v[64:65], v123 offset:7712
    ds_read_b64_tr_b16 v[66:67], v123 offset:7904
    s_waitcnt lgkmcnt(10)
    v_mfma_f32_16x16x32_bf16 v[20:23], v[32:35], v[36:39], v[20:23]
    v_mfma_f32_16x16x32_bf16 v[24:27], v[32:35], v[40:43], v[24:27]
    s_waitcnt lgkmcnt(5)
    v_mfma_f32_16x16x32_bf16 v[20:23], v[44:47], v[48:51], v[20:23]
    v_mfma_f32_16x16x32_bf16 v[24:27], v[44:47], v[52:55], v[24:27]
    s_waitcnt lgkmcnt(0)
    v_mfma_f32_16x16x32_bf16 v[20:23], v[56:59], v[60:63], v[20:23]
    v_mfma_f32_16x16x32_bf16 v[24:27], v[56:59], v[64:67], v[24:27]
    s_nop 6
    v_cvt_pk_bf16_f32 v28, v20, v21
    v_cvt_pk_bf16_f32 v29, v22, v23
    v_cvt_pk_bf16_f32 v30, v24, v25
    v_cvt_pk_bf16_f32 v31, v26, v27
    buffer_store_dwordx2 v[28:29], v16, s[32:35], s61 offen offset:1024 sc1
    v_cndmask_b32 v30, v30, v2, vcc
    v_cndmask_b32 v31, v31, v2, vcc
    s_mov_b64 exec, s[76:77]
    buffer_store_dwordx2 v[30:31], v16, s[32:35], s61 offen offset:1280 sc1
    s_mov_b64 exec, -1
    s_branch L_setup
L_bulk:
    s_lshl_b32 s59, s55, 1
    s_add_u32 s59, s59, s52
    s_add_u32 s59, s59, 1
    s_and_b32 s59, s59, 7
    s_lshl_b32 s70, s59, 10
    s_add_u32 s70, s70, 87552
    s_mul_i32 s71, s59, 9216
    s_and_b32 s59, s59, 1
    s_lshl_b32 s59, s59, 6
    v_xor_b32 v3, s59, v3
    v_mul_u32_u24 v4, 27, v1
    v_lshrrev_b32 v4, 9, v4
    v_mul_u32_u24 v5, 19, v4
    v_sub_u32 v5, v1, v5
    v_min_u32 v5, 17, v5
    v_cmp_le_u32 vcc, 9, v5
    v_lshlrev_b32 v4, 1, v4
    v_subrev_u32 v6, 9, v5
    v_cndmask_b32 v5, v5, v6, vcc
    v_addc_co_u32 v4, vcc, 0, v4, vcc
    v_mul_u32_u24 v7, 1152, v4
    v_lshl_add_u32 v7, v5, 4, v7
    s_mul_i32 s90, s54, 144
    v_add_u32 v7, s90, v7
    v_mov_b32 v118, 0
    v_mov_b32 v119, 0
    s_mul_i32 s61, s92, 3648
    s_mul_i32 s62, s92, 27648
    s_waitcnt lgkmcnt(0)
    s_mov_b32 s20, s4
    s_mov_b32 s21, s5
    s_mov_b32 s22, 2359296
    s_mov_b32 s23, 0x00020000
    s_mov_b32 s48, s16
    s_mov_b32 s49, s17
    s_mov_b32 s50, 256
    s_mov_b32 s51, 0x00020000
    s_mov_b32 s24, s6
    s_mov_b32 s25, s7
    s_mov_b32 s26, 663552
    s_mov_b32 s27, 0x00020000
    s_mov_b32 s32, s18
    s_mov_b32 s33, s19
    s_mov_b32 s34, 262144
    s_mov_b32 s35, 0x00020000
    s_add_u32 s36, s18, 262144
    s_addc_u32 s37, s19, 0
    s_mov_b32 s38, 2359296
    s_mov_b32 s39, 0x00020000
    s_mov_b32 s40, s12
    s_mov_b32 s41, s13
    s_mov_b32 s42, 663552
    s_mov_b32 s43, 0x00020000
    s_mov_b32 s44, s14
    s_mov_b32 s45, s15
    s_mov_b32 s46, 2359296
    s_mov_b32 s47, 0x00020000
L_setup:
    s_lshr_b32 s91, s52, 2
    s_and_b32 s75, s57, 1
    s_mul_i32 s87, s58, 75776
    v_and_b32 v4, 31, v1
    v_lshrrev_b32 v5, 1, v4
    v_and_b32 v5, 7, v5
    v_lshrrev_b32 v6, 5, v1
    s_lshl_b32 s59, s58, 5
    v_add_u32 v4, s59, v4
    v_add_u32 v8, 0, v6
    v_xor_b32 v8, v8, v5
    v_lshlrev_b32 v8, 4, v8
    v_lshl_add_u32 v10, v4, 7, v8
    v_add_u32 v10, 153088, v10
    v_add_u32 v8, 2, v6
    v_xor_b32 v8, v8, v5
    v_lshlrev_b32 v8, 4, v8
    v_lshl_add_u32 v11, v4, 7, v8
    v_add_u32 v11, 153088, v11
    v_add_u32 v8, 4, v6
    v_xor_b32 v8, v8, v5
    v_lshlrev_b32 v8, 4, v8
    v_lshl_add_u32 v12, v4, 7, v8
    v_add_u32 v12, 153088, v12
    v_add_u32 v8, 6, v6
    v_xor_b32 v8, v8, v5
    v_lshlrev_b32 v8, 4, v8
    v_lshl_add_u32 v13, v4, 7, v8
    v_add_u32 v13, 153088, v13
    v_mul_u32_u24 v4, 1216, v6
    v_bfe_u32 v5, v1, 3, 1
    v_mul_u32_u24 v5, 304, v5
    v_add_u32 v4, v4, v5
    v_bfe_u32 v5, v1, 2, 1
    v_mul_u32_u24 v5, 144, v5
    v_add_u32 v4, v4, v5
    v_and_b32 v5, 3, v1
    v_bfe_u32 v8, v1, 4, 1
    v_lshl_add_u32 v5, v8, 2, v5
    v_lshlrev_b32 v5, 2, v5
    s_mov_b32 s59, 0x43120
    s_mov_b32 s60, 0x4423120
    s_cmp_eq_u32 s75, 1
    s_cselect_b32 s59, s60, s59
    s_mul_i32 s60, s57, 36
    s_and_b32 s60, s60, 0xf8
    v_lshrrev_b32 v5, v5, s59
    v_and_b32 v5, 15, v5
    v_lshl_add_u32 v14, v5, 3, v4
    v_add_u32 v14, s60, v14
    v_add_u32 v8, 0x8000, v14
    s_mul_i32 s65, s58, 74
    s_add_u32 s65, s65, s57
    s_lshl_b32 s65, s65, 10
    s_mov_b32 s94, 0x3eae1a93
    s_mov_b32 s95, 0x3eae1a93
    v_lshrrev_b32 v4, 1, v1
    v_lshlrev_b32 v4, 7, v4
    v_and_b32 v5, 1, v1
    v_lshl_add_u32 v144, v5, 4, v4
    v_add_u32 v144, 196608, v144
    v_and_b32 v4, 31, v1
    v_lshlrev_b32 v126, 2, v4
    v_lshrrev_b32 v5, 2, v4
    v_lshlrev_b32 v5, 2, v5
    s_mov_b32 s59, 0x42130
    v_lshrrev_b32 v5, v5, s59
    v_and_b32 v5, 15, v5
    v_and_b32 v6, 3, v4
    v_lshl_add_u32 v5, v5, 2, v6
    v_lshrrev_b32 v6, 5, v1
    v_mul_u32_u24 v2, 304, v6
    v_lshl_add_u32 v125, v5, 4, v2
    v_mov_b32 v2, 0x80000
    v_cmp_gt_u32 vcc, 19, v4
    v_mov_b32 v127, 0xdddd
    v_mov_b32 v124, v15
    v_cndmask_b32 v125, v2, v125, vcc
    v_mov_b32 v161, 0x3f803f80
    v_mov_b32 v177, 0x3f803f80
    v_mov_b32 v4, 0
    v_mov_b32 v5, 0
    v_pk_mov_b32 v[164:165], v[4:5], v[4:5]
    v_pk_mov_b32 v[166:167], v[4:5], v[4:5]
    v_pk_mov_b32 v[180:181], v[4:5], v[4:5]
    v_pk_mov_b32 v[182:183], v[4:5], v[4:5]
    v_pk_mov_b32 v[184:185], v[4:5], v[4:5]
    v_pk_mov_b32 v[186:187], v[4:5], v[4:5]
    v_pk_mov_b32 v[188:189], v[4:5], v[4:5]
    v_pk_mov_b32 v[190:191], v[4:5], v[4:5]
    v_pk_mov_b32 v[192:193], v[4:5], v[4:5]
    v_pk_mov_b32 v[194:195], v[4:5], v[4:5]
    v_pk_mov_b32 v[196:197], v[4:5], v[4:5]
    v_pk_mov_b32 v[198:199], v[4:5], v[4:5]
    v_pk_mov_b32 v[200:201], v[4:5], v[4:5]
    v_pk_mov_b32 v[202:203], v[4:5], v[4:5]
    v_pk_mov_b32 v[204:205], v[4:5], v[4:5]
    v_pk_mov_b32 v[206:207], v[4:5], v[4:5]
    v_pk_mov_b32 v[208:209], v[4:5], v[4:5]
    v_pk_mov_b32 v[210:211], v[4:5], v[4:5]
    s_mul_i32 s60, s52, 1280
    s_add_u32 s60, s60, 153088
    v_add_u32 v129, s60, v15
    v_lshl_add_u32 v130, v1, 3, s60
    s_and_b32 s60, s52, 6
    s_mul_i32 s60, s60, 1280
    s_add_u32 s60, s60, 153088
    v_add_u32 v131, s60, v15
    v_lshl_add_u32 v132, v1, 3, s60
    v_lshl_add_u32 v132, v6, 10, v132
    v_mov_b32 v133, 163328
    s_lshl_b32 s59, s53, 1
    s_add_u32 s59, s59, s58
    s_mul_i32 s59, s59, 36864
    s_lshl_b32 s60, s54, 2
    s_add_u32 s60, s60, s57
    s_lshl_b32 s60, s60, 10
    s_add_u32 s67, s59, s60
    s_and_b32 s60, s54, 1
    s_lshl_b32 s60, s60, 1
    s_xor_b32 s60, s60, s57
    s_lshl_b32 s60, s60, 2
    s_lshl_b32 s63, s54, 9
    s_add_u32 s60, s60, s63
    s_add_u32 s60, s60, s59
    s_add_u32 s68, s60, 32768
    s_and_b32 s63, s52, 3
    s_mul_i32 s85, s52, 960
    s_mul_i32 s86, s52, 6912
    v_mov_b32 v212, -1
    v_mov_b32 v213, -1
    v_mov_b32 v214, -1
    v_mov_b32 v215, -1
    v_and_b32 v178, 7, v1
    v_lshlrev_b32 v178, 3, v178
    s_lshl_b32 s84, s53, 7
    s_add_u32 s84, s84, 163840
    v_mul_u32_u24 v4, 13, v1
    v_lshrrev_b32 v4, 7, v4
    v_mul_u32_u24 v5, 10, v4
    v_sub_u32 v5, v1, v5
    v_min_u32 v5, 8, v5
    v_mul_u32_u24 v128, 1152, v4
    v_lshl_add_u32 v128, v5, 4, v128
    v_add_u32 v128, s90, v128
    s_mul_i32 s59, s57, 2560
    s_add_u32 s59, s59, 46336
    s_add_u32 s60, s87, s59
    v_add_u32 v134, s60, v15
    s_sub_u32 s60, 75776, s87
    s_add_u32 s60, s60, s59
    v_add_u32 v135, s60, v15
    v_and_b32 v6, 15, v1
    v_lshrrev_b32 v5, 4, v1
    s_lshl_b32 s59, s58, 4
    v_add_u32 v2, s59, v6
    v_lshlrev_b32 v2, 4, v2
    v_lshl_add_u32 v143, v5, 9, v2
    v_lshrrev_b32 v179, 5, v1
    v_bfe_u32 v4, v1, 4, 1
    v_lshl_add_u32 v142, v179, 10, v2
    v_lshl_add_u32 v142, v4, 9, v142
    s_lshl_b32 s59, s53, 1
    s_add_u32 s59, s59, s75
    s_mul_i32 s59, s59, 36864
    s_lshl_b32 s60, s91, 14
    s_add_u32 s88, s59, s60
    s_lshl_b32 s60, s91, 11
    s_add_u32 s89, s59, s60
    s_add_u32 s89, s89, 32768
    s_lshl_b32 s59, s53, 6
    s_lshl_b32 s60, s63, 4
    s_add_u32 s59, s59, s60
    v_add_u32 v6, s59, v6
    v_mul_u32_u24 v6, 1152, v6
    v_lshl_add_u32 v141, v5, 3, v6
    v_lshl_add_u32 v219, v4, 5, v6
    v_lshl_add_u32 v219, v179, 4, v219
    s_mul_i32 s59, s75, 75776
    s_mul_i32 s60, s58, 5120
    s_add_u32 s59, s59, s60
    s_add_u32 s59, s59, 56832
    v_add_u32 v140, s59, v15
    v_bfe_u32 v2, v1, 2, 2
    v_mul_u32_u24 v6, 18, v179
    v_add_u32 v6, v6, v2
    v_mul_u32_u24 v136, 12, v4
    v_lshl_add_u32 v137, v4, 2, 4
    v_add_u32 v136, v6, v136
    v_add_u32 v137, v6, v137
    v_mul_u32_u24 v6, 72, v5
    v_and_b32 v179, 1, v2
    v_add3_u32 v6, v6, v179, 16
    v_lshrrev_b32 v2, 1, v2
    v_lshl_add_u32 v2, v4, 1, v2
    v_xor_b32 v179, 2, v2
    v_mad_u32_u24 v138, v2, 18, v6
    v_mad_u32_u24 v139, v179, 18, v6
    v_and_b32 v2, 3, v1
    v_lshlrev_b32 v2, 3, v2
    s_mul_i32 s59, s91, 75776
    v_add_u32 v2, s59, v2
    s_movk_i32 s59, 160
    v_mad_u32_u24 v136, v136, s59, v2
    v_mad_u32_u24 v137, v137, s59, v2
    v_mad_u32_u24 v138, v138, s59, v2
    v_mad_u32_u24 v139, v139, s59, v2
    s_cmp_eq_u32 s52, 0
    s_cbranch_scc1 L_flag
L_issue:
    s_setprio 2
    s_add_u32 s64, s62, s96
    s_cmp_eq_u32 s52, 7
    s_cbranch_scc1 L_b7_0
    s_add_u32 m0, s70, 65536
    s_add_u32 s59, s71, s99
    buffer_load_dwordx4 v3, s[20:23], s59 offen offset:0 lds
    s_add_u32 m0, s70, -128
    s_add_u32 s59, s71, s99
    buffer_load_dwordx4 v3, s[20:23], s59 offen offset:128 lds
    s_add_u32 m0, s70, 7936
    s_add_u32 s59, s71, s99
    buffer_load_dwordx4 v3, s[20:23], s59 offen offset:256 lds
    s_mov_b32 exec_hi, 0x1ffffff
    s_branch L_bc_0
L_b7_0:
    s_mov_b32 exec_hi, 0x1ffffff
    s_add_u32 m0, s61, 3648
    s_add_u32 s59, s64, 27648
    buffer_load_dwordx4 v7, s[24:27], s59 offen lds
    s_add_u32 m0, s61, 4560
    s_add_u32 s59, s64, 34560
    buffer_load_dwordx4 v7, s[24:27], s59 offen lds
    s_add_u32 m0, s61, 5472
    s_add_u32 s59, s64, 41472
    buffer_load_dwordx4 v7, s[24:27], s59 offen lds
    s_add_u32 m0, s61, 6384
    s_add_u32 s59, s64, 48384
    buffer_load_dwordx4 v7, s[24:27], s59 offen lds
L_bc_0:
    s_add_u32 m0, s61, 0
    s_add_u32 s59, s64, 0
    buffer_load_dwordx4 v7, s[24:27], s59 offen lds
    s_add_u32 m0, s61, 912
    s_add_u32 s59, s64, 6912
    buffer_load_dwordx4 v7, s[24:27], s59 offen lds
    s_add_u32 m0, s61, 1824
    s_add_u32 s59, s64, 13824
    buffer_load_dwordx4 v7, s[24:27], s59 offen lds
    s_add_u32 m0, s61, 2736
    s_add_u32 s59, s64, 20736
    buffer_load_dwordx4 v7, s[24:27], s59 offen lds
    s_mov_b32 exec_hi, -1
    s_setprio 0
    s_add_u32 s64, s62, s97
    s_cmp_eq_u32 s52, 7
    s_cbranch_scc1 L_b7_1
    s_add_u32 m0, s70, 16384
    s_add_u32 s59, s71, s100
    buffer_load_dwordx4 v3, s[20:23], s59 offen offset:0 lds
    s_add_u32 m0, s70, 24448
    s_add_u32 s59, s71, s100
    buffer_load_dwordx4 v3, s[20:23], s59 offen offset:128 lds
    s_add_u32 m0, s70, 32512
    s_add_u32 s59, s71, s100
    buffer_load_dwordx4 v3, s[20:23], s59 offen offset:256 lds
    s_mov_b32 exec_hi, 0x1ffffff
    s_branch L_bc_1
L_b7_1:
    s_mov_b32 exec_hi, 0x1ffffff
    s_add_u32 m0, s61, 62016
    s_add_u32 s59, s64, 27648
    buffer_load_dwordx4 v7, s[24:27], s59 offen lds
    s_add_u32 m0, s61, 62928
    s_add_u32 s59, s64, 34560
    buffer_load_dwordx4 v7, s[24:27], s59 offen lds
    s_add_u32 m0, s61, 63840
    s_add_u32 s59, s64, 41472
    buffer_load_dwordx4 v7, s[24:27], s59 offen lds
    s_add_u32 m0, s61, 64752
    s_add_u32 s59, s64, 48384
    buffer_load_dwordx4 v7, s[24:27], s59 offen lds
L_bc_1:
    s_add_u32 m0, s61, 58368
    s_add_u32 s59, s64, 0
    buffer_load_dwordx4 v7, s[24:27], s59 offen lds
    s_add_u32 m0, s61, 59280
    s_add_u32 s59, s64, 6912
    buffer_load_dwordx4 v7, s[24:27], s59 offen lds
    s_add_u32 m0, s61, 60192
    s_add_u32 s59, s64, 13824
    buffer_load_dwordx4 v7, s[24:27], s59 offen lds
    s_add_u32 m0, s61, 61104
    s_add_u32 s59, s64, 20736
    buffer_load_dwordx4 v7, s[24:27], s59 offen lds
    s_mov_b32 exec_hi, -1
    s_cmp_eq_u32 s52, 7
    s_cbranch_scc1 L_nox2
    s_add_u32 m0, s70, 40960
    s_add_u32 s59, s71, s101
    buffer_load_dwordx4 v3, s[20:23], s59 offen offset:0 lds
    s_add_u32 m0, s70, 49024
    s_add_u32 s59, s71, s101
    buffer_load_dwordx4 v3, s[20:23], s59 offen offset:128 lds
    s_add_u32 m0, s70, 57088
    s_add_u32 s59, s71, s101
    buffer_load_dwordx4 v3, s[20:23], s59 offen offset:256 lds
L_nox2:
L_wait:
    s_cmp_eq_u32 s52, 7
    s_cbranch_scc1 L_x2w8
    s_waitcnt vmcnt(10)
    s_branch L_join
L_x2w8:
    s_waitcnt vmcnt(8)
    s_branch L_join
L_flag:
    s_getreg_b32 s59, hwreg(HW_REG_XCC_ID, 0, 4)
    s_mov_b32 s66, 0
    v_mov_b32 v6, 0
    s_waitcnt vmcnt(0)
L_nonce:
    v_readfirstlane_b32 s72, v118
    v_readfirstlane_b32 s73, v119
    s_add_u32 s66, s66, 1
    s_cmp_gt_u32 s66, 131072
    s_cbranch_scc1 L_gotnonce
    s_cmp_lg_u32 s72, 0
    s_cbranch_scc1 L_gotnonce
    buffer_load_dwordx2 v[118:119], v6, s[48:51], 0 offen sc1
    s_waitcnt vmcnt(0)
    s_branch L_nonce
L_gotnonce:
    s_and_b32 s73, s73, 0x0fffffff
    s_and_b32 s60, s59, 7
    s_lshl_b32 s60, s60, 13
    v_add_u32 v144, s60, v144
    v_lshlrev_b32 v6, 13, v1
    s_lshl_b32 s59, s59, 28
    s_or_b32 s74, s73, s59
    s_lshl_b32 s59, s53, 8
    s_lshl_b32 s60, s56, 7
    s_add_u32 s59, s59, s60
    s_lshl_b32 s60, s55, 3
    s_add_u32 s59, s59, s60
    s_add_u32 s59, s59, 196608
    v_mov_b32 v4, s72
    v_mov_b32 v5, s74
    s_mov_b64 exec, 0xff
    buffer_store_dwordx2 v[4:5], v6, s[32:35], s59 offen sc1
    s_mov_b64 exec, -1
    s_setprio 0
L_join:
    s_mul_i32 s61, s52, 3648
    s_mul_i32 s62, s52, 27648
    s_add_u32 s64, s62, s98
    s_barrier
    ds_read_b64_tr_b16 v[32:33], v14 offset:0
    ds_read_b64_tr_b16 v[34:35], v14 offset:608
    ds_read_b128 v[36:39], v10 offset:0
    ds_read_b64_tr_b16 v[40:41], v14 offset:2432
    ds_read_b64_tr_b16 v[42:43], v14 offset:3040
    ds_read_b128 v[44:47], v11 offset:0
    ds_read_b64_tr_b16 v[48:49], v14 offset:4864
    ds_read_b64_tr_b16 v[50:51], v14 offset:5472
    ds_read_b128 v[52:55], v12 offset:0
    ds_read_b64_tr_b16 v[56:57], v14 offset:7296
    ds_read_b64_tr_b16 v[58:59], v14 offset:7904
    ds_read_b128 v[60:63], v13 offset:0
    s_waitcnt lgkmcnt(9)
    v_mfma_f32_32x32x16_bf16 v[16:31], v[32:35], v[36:39], 0
    s_mov_b32 exec_hi, 0x1ffffff
    s_add_u32 m0, s61, 29184
    s_add_u32 s59, s64, 0
    buffer_load_dwordx4 v7, s[24:27], s59 offen lds
    s_mov_b32 exec_hi, -1
    v_subrev_u32 v10, 0x10000, v10
    v_subrev_u32 v11, 0x10000, v11
    v_subrev_u32 v12, 0x10000, v12
    v_subrev_u32 v13, 0x10000, v13
    ds_read_b64_tr_b16 v[32:33], v14 offset:9728
    ds_read_b64_tr_b16 v[34:35], v14 offset:10336
    ds_read_b128 v[36:39], v10 offset:0
    s_waitcnt lgkmcnt(9)
    v_mfma_f32_32x32x16_bf16 v[16:31], v[40:43], v[44:47], v[16:31]
    s_mov_b32 exec_hi, 0x1ffffff
    s_add_u32 m0, s61, 30096
    s_add_u32 s59, s64, 6912
    buffer_load_dwordx4 v7, s[24:27], s59 offen lds
    s_mov_b32 exec_hi, -1
    ds_read_b64_tr_b16 v[40:41], v14 offset:12160
    ds_read_b64_tr_b16 v[42:43], v14 offset:12768
    ds_read_b128 v[44:47], v11 offset:0
    s_waitcnt lgkmcnt(9)
    v_mfma_f32_32x32x16_bf16 v[16:31], v[48:51], v[52:55], v[16:31]
    s_mov_b32 exec_hi, 0x1ffffff
    s_add_u32 m0, s61, 31008
    s_add_u32 s59, s64, 13824
    buffer_load_dwordx4 v7, s[24:27], s59 offen lds
    s_mov_b32 exec_hi, -1
    ds_read_b64_tr_b16 v[48:49], v14 offset:14592
    ds_read_b64_tr_b16 v[50:51], v14 offset:15200
    ds_read_b128 v[52:55], v12 offset:0
    s_waitcnt lgkmcnt(9)
    v_mfma_f32_32x32x16_bf16 v[16:31], v[56:59], v[60:63], v[16:31]
    s_mov_b32 exec_hi, 0x1ffffff
    s_add_u32 m0, s61, 31920
    s_add_u32 s59, s64, 20736
    buffer_load_dwordx4 v7, s[24:27], s59 offen lds
    s_mov_b32 exec_hi, -1
    ds_read_b64_tr_b16 v[56:57], v14 offset:17024
    ds_read_b64_tr_b16 v[58:59], v14 offset:17632
    ds_read_b128 v[60:63], v13 offset:0
    s_waitcnt lgkmcnt(9)
    v_mfma_f32_32x32x16_bf16 v[16:31], v[32:35], v[36:39], v[16:31]
    ds_read_b64_tr_b16 v[32:33], v14 offset:19456
    ds_read_b64_tr_b16 v[34:35], v14 offset:20064
    ds_read_b128 v[36:39], v10 offset:8192
    s_waitcnt lgkmcnt(9)
    v_mfma_f32_32x32x16_bf16 v[16:31], v[40:43], v[44:47], v[16:31]
    ds_read_b64_tr_b16 v[40:41], v14 offset:21888
    ds_read_b64_tr_b16 v[42:43], v14 offset:22496
    ds_read_b128 v[44:47], v11 offset:8192
    s_waitcnt lgkmcnt(9)
    v_mfma_f32_32x32x16_bf16 v[16:31], v[48:51], v[52:55], v[16:31]
    ds_read_b64_tr_b16 v[48:49], v14 offset:24320
    ds_read_b64_tr_b16 v[50:51], v14 offset:24928
    ds_read_b128 v[52:55], v12 offset:8192
    s_waitcnt lgkmcnt(9)
    v_mfma_f32_32x32x16_bf16 v[16:31], v[56:59], v[60:63], v[16:31]
    ds_read_b64_tr_b16 v[56:57], v14 offset:26752
    ds_read_b64_tr_b16 v[58:59], v14 offset:27360
    ds_read_b128 v[60:63], v13 offset:8192
    s_waitcnt lgkmcnt(9)
    v_mfma_f32_32x32x16_bf16 v[16:31], v[32:35], v[36:39], v[16:31]
    s_cmp_lt_u32 s92, 6
    s_cbranch_scc1 L_w7
    s_waitcnt vmcnt(4)
    s_branch L_w4
L_w7:
    s_waitcnt vmcnt(7)
L_w4:
    s_barrier
    ds_read_b64_tr_b16 v[32:33], v8 offset:25600
    ds_read_b64_tr_b16 v[34:35], v8 offset:26208
    ds_read_b128 v[36:39], v10 offset:16384
    s_waitcnt lgkmcnt(9)
    v_mfma_f32_32x32x16_bf16 v[16:31], v[40:43], v[44:47], v[16:31]
    ds_read_b64_tr_b16 v[40:41], v8 offset:28032
    ds_read_b64_tr_b16 v[42:43], v8 offset:28640
    ds_read_b128 v[44:47], v11 offset:16384
    s_waitcnt lgkmcnt(9)
    v_mfma_f32_32x32x16_bf16 v[16:31], v[48:51], v[52:55], v[16:31]
    ds_read_b64_tr_b16 v[48:49], v8 offset:30464
    ds_read_b64_tr_b16 v[50:51], v8 offset:31072
    ds_read_b128 v[52:55], v12 offset:16384
    s_waitcnt lgkmcnt(9)
    v_mfma_f32_32x32x16_bf16 v[16:31], v[56:59], v[60:63], v[16:31]
    ds_read_b64_tr_b16 v[56:57], v8 offset:32896
    ds_read_b64_tr_b16 v[58:59], v8 offset:33504
    ds_read_b128 v[60:63], v13 offset:16384
    s_waitcnt lgkmcnt(9)
    v_mfma_f32_32x32x16_bf16 v[16:31], v[32:35], v[36:39], v[16:31]
    ds_read_b64_tr_b16 v[32:33], v8 offset:35328
    ds_read_b64_tr_b16 v[34:35], v8 offset:35936
    ds_read_b128 v[36:39], v10 offset:24576
    s_waitcnt lgkmcnt(9)
    v_mfma_f32_32x32x16_bf16 v[16:31], v[40:43], v[44:47], v[16:31]
    ds_read_b64_tr_b16 v[40:41], v8 offset:37760
    ds_read_b64_tr_b16 v[42:43], v8 offset:38368
    ds_read_b128 v[44:47], v11 offset:24576
    s_waitcnt lgkmcnt(9)
    v_mfma_f32_32x32x16_bf16 v[16:31], v[48:51], v[52:55], v[16:31]
    ds_read_b64_tr_b16 v[48:49], v8 offset:40192
    ds_read_b64_tr_b16 v[50:51], v8 offset:40800
    ds_read_b128 v[52:55], v12 offset:24576
    s_waitcnt lgkmcnt(9)
    v_mfma_f32_32x32x16_bf16 v[16:31], v[56:59], v[60:63], v[16:31]
    ds_read_b64_tr_b16 v[56:57], v8 offset:42624
    ds_read_b64_tr_b16 v[58:59], v8 offset:43232
    ds_read_b128 v[60:63], v13 offset:24576
    s_waitcnt lgkmcnt(9)
    v_mfma_f32_32x32x16_bf16 v[16:31], v[32:35], v[36:39], v[16:31]
    ds_read_b64_tr_b16 v[32:33], v8 offset:45056
    ds_read_b64_tr_b16 v[34:35], v8 offset:45664
    ds_read_b128 v[36:39], v10 offset:32768
    s_waitcnt lgkmcnt(9)
    v_mfma_f32_32x32x16_bf16 v[16:31], v[40:43], v[44:47], v[16:31]
    ds_read_b64_tr_b16 v[40:41], v8 offset:47488
    ds_read_b64_tr_b16 v[42:43], v8 offset:48096
    ds_read_b128 v[44:47], v11 offset:32768
    s_waitcnt lgkmcnt(9)
    v_mfma_f32_32x32x16_bf16 v[16:31], v[48:51], v[52:55], v[16:31]
    s_cmp_lg_u32 s52, 0
    s_cbranch_scc1 L_nopoll
    buffer_load_dwordx4 v[104:107], v144, s[32:35], 0 offen sc1
    s_movk_i32 s60, 0x1000
    buffer_load_dwordx4 v[108:111], v144, s[32:35], s60 offen sc1
L_nopoll:
    ds_read_b64_tr_b16 v[48:49], v8 offset:49920
    ds_read_b64_tr_b16 v[50:51], v8 offset:50528
    ds_read_b128 v[52:55], v12 offset:32768
    s_waitcnt lgkmcnt(9)
    v_mfma_f32_32x32x16_bf16 v[16:31], v[56:59], v[60:63], v[16:31]
    ds_read_b64_tr_b16 v[56:57], v8 offset:52352
    ds_read_b64_tr_b16 v[58:59], v8 offset:52960
    ds_read_b128 v[60:63], v13 offset:32768
    s_waitcnt lgkmcnt(9)
    v_mfma_f32_32x32x16_bf16 v[16:31], v[32:35], v[36:39], v[16:31]
    s_cmp_lg_u32 s52, 0
    s_cbranch_scc1 L_polled
    s_mov_b32 s66, 0
    s_waitcnt vmcnt(0)
    v_xor_b32 v4, s72, v104
    v_xor_b32 v5, s72, v106
    v_xor_b32 v6, s72, v108
    v_or3_b32 v4, v4, v5, v6
    v_xor_b32 v2, s72, v110
    v_xor_b32 v5, s74, v105
    v_xor_b32 v6, s74, v107
    v_or_b32 v112, v5, v6
    v_xor_b32 v5, s74, v109
    v_xor_b32 v6, s74, v111
    v_or_b32 v113, v5, v6
    v_or_b32 v5, v112, v113
    v_and_b32 v5, 0x0fffffff, v5
    v_or3_b32 v4, v4, v2, v5
    s_add_u32 s66, s66, 1
    v_cmp_ne_u32 vcc, 0, v4
    s_mov_b64 s[82:83], vcc
    v_mov_b32 v2, 0
    s_cbranch_vccnz L_notyet
    v_cmp_eq_u32 vcc, 0, v112
    v_cmp_eq_u32 s[76:77], 0, v113
    s_cmp_ge_u32 s53, 16
    s_cselect_b64 s[76:77], s[76:77], vcc
    s_and_b32 s59, s53, 15
    s_lshl_b32 s59, s59, 2
    s_lshr_b64 s[76:77], s[76:77], s59
    s_and_b32 s59, s76, 15
    v_mov_b32 v4, s59
    v_mov_b32 v5, s72
    v_mov_b32 v6, s73
    ds_write_b96 v133, v[4:6]
    v_mov_b32 v2, 1
L_notyet:
    ds_write_b32 v133, v2 offset:16
L_polled:
    s_waitcnt vmcnt(0) lgkmcnt(0)
    s_barrier
    ds_read_b32 v2, v133 offset:16
    ds_read_b64_tr_b16 v[32:33], v14 offset:29184
    ds_read_b64_tr_b16 v[34:35], v14 offset:29792
    ds_read_b128 v[36:39], v10 offset:40960
    s_waitcnt lgkmcnt(9)
    v_mfma_f32_32x32x16_bf16 v[16:31], v[40:43], v[44:47], v[16:31]
    ds_read_b64_tr_b16 v[40:41], v14 offset:31616
    ds_read_b64_tr_b16 v[42:43], v14 offset:32224
    ds_read_b128 v[44:47], v11 offset:40960
    s_waitcnt lgkmcnt(9)
    v_mfma_f32_32x32x16_bf16 v[16:31], v[48:51], v[52:55], v[16:31]
    s_waitcnt lgkmcnt(6)
    v_readfirstlane_b32 s59, v2
    s_cmp_eq_u32 s59, 1
    s_cbranch_scc0 L_late
    buffer_load_dwordx4 v[156:159], v124, s[32:35], 0 offen sc1
    buffer_load_dword v160, v126, s[32:35], 0 offen offset:2240 sc1
    s_mov_b32 m0, s65
    s_add_u32 s65, s65, 4096
    buffer_load_dwordx4 v15, s[32:35], m0 offen sc1 lds
    s_mov_b32 m0, s65
    s_add_u32 s65, s65, 4096
    buffer_load_dwordx4 v15, s[32:35], m0 offen sc1 lds
    ds_read_b64_tr_b16 v[48:49], v8 offset:1280
    ds_read_b64_tr_b16 v[50:51], v8 offset:1888
    ds_read_b128 v[52:55], v12 offset:40960
    s_waitcnt lgkmcnt(9)
    v_mfma_f32_32x32x16_bf16 v[16:31], v[56:59], v[60:63], v[16:31]
    s_mov_b32 m0, s65
    s_add_u32 s65, s65, 4096
    buffer_load_dwordx4 v15, s[32:35], m0 offen sc1 lds
    ds_read_b64_tr_b16 v[56:57], v8 offset:3712
    ds_read_b64_tr_b16 v[58:59], v8 offset:4320
    ds_read_b128 v[60:63], v13 offset:40960
    s_waitcnt lgkmcnt(9)
    v_mfma_f32_32x32x16_bf16 v[16:31], v[32:35], v[36:39], v[16:31]
    s_mov_b32 m0, s65
    s_add_u32 s65, s65, 4096
    buffer_load_dwordx4 v15, s[32:35], m0 offen sc1 lds
    ds_read_b64_tr_b16 v[32:33], v8 offset:6144
    ds_read_b64_tr_b16 v[34:35], v8 offset:6752
    ds_read_b128 v[36:39], v10 offset:49152
    s_waitcnt lgkmcnt(9)
    v_mfma_f32_32x32x16_bf16 v[16:31], v[40:43], v[44:47], v[16:31]
    s_mov_b32 m0, s65
    s_add_u32 s65, s65, 4096
    buffer_load_dwordx4 v15, s[32:35], m0 offen sc1 lds
    ds_read_b64_tr_b16 v[40:41], v8 offset:8576
    ds_read_b64_tr_b16 v[42:43], v8 offset:9184
    ds_read_b128 v[44:47], v11 offset:49152
    s_waitcnt lgkmcnt(9)
    v_mfma_f32_32x32x16_bf16 v[16:31], v[48:51], v[52:55], v[16:31]
    ds_read_b64_tr_b16 v[48:49], v8 offset:11008
    ds_read_b64_tr_b16 v[50:51], v8 offset:11616
    ds_read_b128 v[52:55], v12 offset:49152
    s_waitcnt lgkmcnt(9)
    v_mfma_f32_32x32x16_bf16 v[16:31], v[56:59], v[60:63], v[16:31]
    s_mov_b32 m0, s65
    s_add_u32 s65, s65, 4096
    buffer_load_dwordx4 v15, s[32:35], m0 offen sc1 lds
    ds_read_b64_tr_b16 v[56:57], v8 offset:13440
    ds_read_b64_tr_b16 v[58:59], v8 offset:14048
    ds_read_b128 v[60:63], v13 offset:49152
    s_waitcnt lgkmcnt(9)
    v_mfma_f32_32x32x16_bf16 v[16:31], v[32:35], v[36:39], v[16:31]
    ds_read_b64_tr_b16 v[32:33], v8 offset:15872
    ds_read_b64_tr_b16 v[34:35], v8 offset:16480
    ds_read_b128 v[36:39], v10 offset:57344
    s_waitcnt lgkmcnt(9)
    v_mfma_f32_32x32x16_bf16 v[16:31], v[40:43], v[44:47], v[16:31]
    s_mov_b32 m0, s65
    s_add_u32 s65, s65, 4096
    buffer_load_dwordx4 v15, s[32:35], m0 offen sc1 lds
    ds_read_b64_tr_b16 v[40:41], v8 offset:18304
    ds_read_b64_tr_b16 v[42:43], v8 offset:18912
    ds_read_b128 v[44:47], v11 offset:57344
    s_waitcnt lgkmcnt(9)
    v_mfma_f32_32x32x16_bf16 v[16:31], v[48:51], v[52:55], v[16:31]
    ds_read_b64_tr_b16 v[48:49], v8 offset:20736
    ds_read_b64_tr_b16 v[50:51], v8 offset:21344
    ds_read_b128 v[52:55], v12 offset:57344
    s_waitcnt lgkmcnt(9)
    v_mfma_f32_32x32x16_bf16 v[16:31], v[56:59], v[60:63], v[16:31]
    ds_read_b64_tr_b16 v[56:57], v8 offset:23168
    ds_read_b64_tr_b16 v[58:59], v8 offset:23776
    ds_read_b128 v[60:63], v13 offset:57344
    s_waitcnt lgkmcnt(9)
    v_mfma_f32_32x32x16_bf16 v[16:31], v[32:35], v[36:39], v[16:31]
    s_waitcnt lgkmcnt(6)
    v_mfma_f32_32x32x16_bf16 v[16:31], v[40:43], v[44:47], v[16:31]
    s_waitcnt lgkmcnt(3)
    v_mfma_f32_32x32x16_bf16 v[16:31], v[48:51], v[52:55], v[16:31]
    s_waitcnt lgkmcnt(0)
    v_mfma_f32_32x32x16_bf16 v[16:31], v[56:59], v[60:63], v[16:31]
    s_branch L_qend
L_late:
    ds_read_b64_tr_b16 v[48:49], v8 offset:1280
    ds_read_b64_tr_b16 v[50:51], v8 offset:1888
    ds_read_b128 v[52:55], v12 offset:40960
    s_waitcnt lgkmcnt(9)
    v_mfma_f32_32x32x16_bf16 v[16:31], v[56:59], v[60:63], v[16:31]
    ds_read_b64_tr_b16 v[56:57], v8 offset:3712
    ds_read_b64_tr_b16 v[58:59], v8 offset:4320
    ds_read_b128 v[60:63], v13 offset:40960
    s_waitcnt lgkmcnt(9)
    v_mfma_f32_32x32x16_bf16 v[16:31], v[32:35], v[36:39], v[16:31]
    ds_read_b64_tr_b16 v[32:33], v8 offset:6144
    ds_read_b64_tr_b16 v[34:35], v8 offset:6752
    ds_read_b128 v[36:39], v10 offset:49152
    s_waitcnt lgkmcnt(9)
    v_mfma_f32_32x32x16_bf16 v[16:31], v[40:43], v[44:47], v[16:31]
    ds_read_b64_tr_b16 v[40:41], v8 offset:8576
    ds_read_b64_tr_b16 v[42:43], v8 offset:9184
    ds_read_b128 v[44:47], v11 offset:49152
    s_waitcnt lgkmcnt(9)
    v_mfma_f32_32x32x16_bf16 v[16:31], v[48:51], v[52:55], v[16:31]
    ds_read_b64_tr_b16 v[48:49], v8 offset:11008
    ds_read_b64_tr_b16 v[50:51], v8 offset:11616
    ds_read_b128 v[52:55], v12 offset:49152
    s_waitcnt lgkmcnt(9)
    v_mfma_f32_32x32x16_bf16 v[16:31], v[56:59], v[60:63], v[16:31]
    ds_read_b64_tr_b16 v[56:57], v8 offset:13440
    ds_read_b64_tr_b16 v[58:59], v8 offset:14048
    ds_read_b128 v[60:63], v13 offset:49152
    s_waitcnt lgkmcnt(9)
    v_mfma_f32_32x32x16_bf16 v[16:31], v[32:35], v[36:39], v[16:31]
    ds_read_b64_tr_b16 v[32:33], v8 offset:15872
    ds_read_b64_tr_b16 v[34:35], v8 offset:16480
    ds_read_b128 v[36:39], v10 offset:57344
    s_waitcnt lgkmcnt(9)
    v_mfma_f32_32x32x16_bf16 v[16:31], v[40:43], v[44:47], v[16:31]
    ds_read_b64_tr_b16 v[40:41], v8 offset:18304
    ds_read_b64_tr_b16 v[42:43], v8 offset:18912
    ds_read_b128 v[44:47], v11 offset:57344
    s_waitcnt lgkmcnt(9)
    v_mfma_f32_32x32x16_bf16 v[16:31], v[48:51], v[52:55], v[16:31]
    ds_read_b64_tr_b16 v[48:49], v8 offset:20736
    ds_read_b64_tr_b16 v[50:51], v8 offset:21344
    ds_read_b128 v[52:55], v12 offset:57344
    s_waitcnt lgkmcnt(9)
    v_mfma_f32_32x32x16_bf16 v[16:31], v[56:59], v[60:63], v[16:31]
    ds_read_b64_tr_b16 v[56:57], v8 offset:23168
    ds_read_b64_tr_b16 v[58:59], v8 offset:23776
    ds_read_b128 v[60:63], v13 offset:57344
    s_waitcnt lgkmcnt(9)
    v_mfma_f32_32x32x16_bf16 v[16:31], v[32:35], v[36:39], v[16:31]
    s_waitcnt lgkmcnt(6)
    v_mfma_f32_32x32x16_bf16 v[16:31], v[40:43], v[44:47], v[16:31]
    s_waitcnt lgkmcnt(3)
    v_mfma_f32_32x32x16_bf16 v[16:31], v[48:51], v[52:55], v[16:31]
    s_waitcnt lgkmcnt(0)
    v_mfma_f32_32x32x16_bf16 v[16:31], v[56:59], v[60:63], v[16:31]
    s_cmp_lg_u32 s52, 0
    s_cbranch_scc1 L_polled2
    s_mov_b64 vcc, s[82:83]
L_poll:
    s_mov_b64 exec, vcc
    buffer_load_dwordx4 v[104:107], v144, s[32:35], 0 offen sc1
    s_movk_i32 s60, 0x1000
    buffer_load_dwordx4 v[108:111], v144, s[32:35], s60 offen sc1
    s_waitcnt vmcnt(0)
    v_xor_b32 v4, s72, v104
    v_xor_b32 v5, s72, v106
    v_xor_b32 v6, s72, v108
    v_or3_b32 v4, v4, v5, v6
    v_xor_b32 v2, s72, v110
    v_xor_b32 v5, s74, v105
    v_xor_b32 v6, s74, v107
    v_or_b32 v112, v5, v6
    v_xor_b32 v5, s74, v109
    v_xor_b32 v6, s74, v111
    v_or_b32 v113, v5, v6
    v_or_b32 v5, v112, v113
    v_and_b32 v5, 0x0fffffff, v5
    v_or3_b32 v4, v4, v2, v5
    s_add_u32 s66, s66, 1
    v_cmp_ne_u32 vcc, 0, v4
    s_cmp_gt_u32 s66, 131072
    s_cbranch_scc1 L_pollok
    s_cbranch_vccz L_pollok
    s_sleep 2
    s_branch L_poll
L_pollok:
    s_mov_b64 exec, -1
    v_cmp_eq_u32 vcc, 0, v112
    v_cmp_eq_u32 s[76:77], 0, v113
    s_cmp_ge_u32 s53, 16
    s_cselect_b64 s[76:77], s[76:77], vcc
    s_and_b32 s59, s53, 15
    s_lshl_b32 s59, s59, 2
    s_lshr_b64 s[76:77], s[76:77], s59
    s_and_b32 s59, s76, 15
    v_mov_b32 v4, s59
    v_mov_b32 v5, s72
    v_mov_b32 v6, s73
    ds_write_b96 v133, v[4:6]
    s_waitcnt lgkmcnt(0)
L_polled2:
    s_barrier
    buffer_load_dwordx4 v[156:159], v124, s[32:35], 0 offen sc1
    buffer_load_dword v160, v126, s[32:35], 0 offen offset:2240 sc1
    s_mov_b32 m0, s65
    s_add_u32 s65, s65, 4096
    buffer_load_dwordx4 v15, s[32:35], m0 offen sc1 lds
    s_mov_b32 m0, s65
    s_add_u32 s65, s65, 4096
    buffer_load_dwordx4 v15, s[32:35], m0 offen sc1 lds
    s_mov_b32 m0, s65
    s_add_u32 s65, s65, 4096
    buffer_load_dwordx4 v15, s[32:35], m0 offen sc1 lds
    s_mov_b32 m0, s65
    s_add_u32 s65, s65, 4096
    buffer_load_dwordx4 v15, s[32:35], m0 offen sc1 lds
    s_mov_b32 m0, s65
    s_add_u32 s65, s65, 4096
    buffer_load_dwordx4 v15, s[32:35], m0 offen sc1 lds
    s_mov_b32 m0, s65
    s_add_u32 s65, s65, 4096
    buffer_load_dwordx4 v15, s[32:35], m0 offen sc1 lds
    s_mov_b32 m0, s65
    s_add_u32 s65, s65, 4096
    buffer_load_dwordx4 v15, s[32:35], m0 offen sc1 lds
L_qend:
    v_mov_b32 v36, 0
    v_mov_b32 v37, 0
    s_cmp_eq_u32 s75, 1
    s_nop 8
    s_cbranch_scc1 L_qodd
    v_pk_mul_f32 v[16:17], v[16:17], s[94:95]
    v_pk_mul_f32 v[18:19], v[18:19], s[94:95]
    v_pk_mul_f32 v[20:21], v[20:21], s[94:95]
    v_pk_mul_f32 v[22:23], v[22:23], s[94:95]
    v_pk_mul_f32 v[24:25], v[24:25], s[94:95]
    v_cvt_pk_bf16_f32 v32, v16, v17
    v_cvt_pk_bf16_f32 v33, v18, v19
    v_cvt_pk_bf16_f32 v34, v20, v21
    v_cvt_pk_bf16_f32 v35, v22, v23
    s_mov_b32 exec_hi, 0
    v_cvt_pk_bf16_f32 v36, v24, v25
    s_branch L_qdone
L_qodd:
    v_pk_mul_f32 v[18:19], v[18:19], s[94:95]
    v_pk_mul_f32 v[20:21], v[20:21], s[94:95]
    v_pk_mul_f32 v[22:23], v[22:23], s[94:95]
    v_pk_mul_f32 v[24:25], v[24:25], s[94:95]
    v_pk_mul_f32 v[30:31], v[30:31], s[94:95]
    v_cvt_pk_bf16_f32 v32, v18, v19
    v_cvt_pk_bf16_f32 v33, v20, v21
    v_cvt_pk_bf16_f32 v34, v22, v23
    v_cvt_pk_bf16_f32 v35, v24, v25
    s_mov_b32 exec_hi, 0
    v_cvt_pk_bf16_f32 v36, v30, v31
L_qdone:
    s_mov_b32 exec_hi, -1
    s_waitcnt vmcnt(7)
    v_mfma_f32_32x32x16_bf16 v[64:79], v[156:159], v[32:35], 0
    v_mfma_f32_32x32x8_bf16 v[64:79], v[160:161], v[36:37], v[64:79]
    ds_write_b128 v129, v[32:35]
    v_add_u32 v124, s87, v124
    v_add_u32 v125, s87, v125
    v_add_u32 v126, s87, v126
    v_mov_b32 v104, 0
    v_mov_b32 v105, 0
    v_mov_b32 v106, 0
    v_mov_b32 v107, 0
    v_mov_b32 v108, 0
    v_mov_b32 v109, 0
    v_mov_b32 v110, 0
    v_mov_b32 v111, 0
    v_max3_f32 v4, v64, v65, v66
    v_max3_f32 v4, v4, v67, v68
    v_max3_f32 v4, v4, v69, v70
    v_max3_f32 v4, v4, v71, v72
    v_max3_f32 v4, v4, v73, v74
    v_max3_f32 v4, v4, v75, v76
    v_max3_f32 v4, v4, v77, v78
    v_max_f32 v4, v4, v79
    v_mov_b32 v5, v4
    s_nop 1
    v_permlane32_swap_b32 v4, v5
    s_nop 0
    v_max_f32 v4, v4, v5
    s_mov_b32 exec_hi, 0
    v_cvt_pk_bf16_f32 v37, -v4, 0
    ds_write_b64 v130, v[36:37] offset:1024
    s_mov_b32 exec_hi, -1
    s_mov_b32 s66, 0
    s_waitcnt vmcnt(0) lgkmcnt(0)
    s_barrier
    ds_read_b32 v160, v126 offset:2240
    ds_read_b64 v[46:47], v132 offset:1024
    ds_read_b128 v[156:159], v124 offset:0
    ds_read_b128 v[32:35], v131
    ds_read_b128 v[40:43], v131 offset:1280
    ds_read_b96 v[4:6], v133
    ds_read_b32 v176, v126 offset:4608
    ds_read_b128 v[152:155], v125 offset:1024
    ds_read_b128 v[148:151], v125 offset:1632
    ds_read_b128 v[172:175], v124 offset:2368
    ds_read_b128 v[168:171], v125 offset:3392
    s_waitcnt lgkmcnt(9)
    v_mfma_f32_32x32x4_2b_bf16 v[48:79], v[160:161], v[46:47], 0
    s_waitcnt lgkmcnt(3)
    v_readfirstlane_b32 s74, v4
    v_readfirstlane_b32 s72, v5
    v_readfirstlane_b32 s73, v6
    s_nop 13
    v_mfma_f32_32x32x16_bf16 v[48:63], v[156:159], v[32:35], v[48:63]
    v_mfma_f32_32x32x16_bf16 v[64:79], v[156:159], v[40:43], v[64:79]
    s_nop 8
    s_cmp_lt_u32 s52, 4
    s_cselect_b64 vcc, -1, 0
    s_setprio 1
    s_cbranch_vccz L_pr1
    s_setprio 2
L_pr1:
    s_sub_u32 m0, s65, 4096
    v_smfmac_f32_32x32x32_bf16 v[196:211], v[164:167], v[104:111], v127
    v_exp_f32 v48, v48
    v_exp_f32 v49, v49
    v_exp_f32 v50, v50
    v_exp_f32 v51, v51
    s_add_u32 m0, m0, 4096
    v_mfma_f32_32x32x4_2b_bf16 v[80:111], v[176:177], v[46:47], 0
    buffer_load_dwordx4 v15, s[32:35], m0 offen sc1 lds
    ds_read_b32 v160, v126 offset:6976
    v_exp_f32 v52, v52
    v_exp_f32 v53, v53
    v_exp_f32 v54, v54
    v_exp_f32 v55, v55
    v_exp_f32 v56, v56
    v_exp_f32 v57, v57
    v_exp_f32 v58, v58
    v_exp_f32 v59, v59
    v_smfmac_f32_32x32x32_bf16 v[180:195], v[152:155], v[48:55], v127
    v_exp_f32 v60, v60
    v_exp_f32 v61, v61
    v_exp_f32 v62, v62
    v_exp_f32 v63, v63
    s_waitcnt lgkmcnt(0)
    ds_read_b128 v[164:167], v125 offset:4000
    v_smfmac_f32_32x32x32_bf16 v[180:195], v[148:151], v[56:63], v127
    v_exp_f32 v64, v64
    v_exp_f32 v65, v65
    v_exp_f32 v66, v66
    v_exp_f32 v67, v67
    s_add_u32 m0, m0, 4096
    v_mfma_f32_32x32x16_bf16 v[80:95], v[172:175], v[32:35], v[80:95]
    buffer_load_dwordx4 v15, s[32:35], m0 offen sc1 lds
    v_exp_f32 v68, v68
    v_exp_f32 v69, v69
    v_exp_f32 v70, v70
    v_exp_f32 v71, v71
    v_mfma_f32_32x32x16_bf16 v[96:111], v[172:175], v[40:43], v[96:111]
    v_exp_f32 v72, v72
    v_exp_f32 v73, v73
    v_exp_f32 v74, v74
    v_exp_f32 v75, v75
    v_smfmac_f32_32x32x32_bf16 v[196:211], v[152:155], v[64:71], v127
    v_exp_f32 v76, v76
    v_exp_f32 v77, v77
    v_exp_f32 v78, v78
    v_exp_f32 v79, v79
    ds_read_b128 v[156:159], v124 offset:4736
    ds_read_b128 v[152:155], v125 offset:5760
    v_smfmac_f32_32x32x32_bf16 v[196:211], v[148:151], v[72:79], v127
    s_cbranch_vccz L_pr2
    s_setprio 0
L_pr2:
    v_exp_f32 v80, v80
    v_exp_f32 v81, v81
    v_exp_f32 v82, v82
    v_exp_f32 v83, v83
    s_add_u32 m0, m0, 4096
    v_mfma_f32_32x32x4_2b_bf16 v[48:79], v[160:161], v[46:47], 0
    buffer_load_dwordx4 v15, s[32:35], m0 offen sc1 lds
    ds_read_b32 v176, v126 offset:9344
    v_exp_f32 v84, v84
    v_exp_f32 v85, v85
    v_exp_f32 v86, v86
    v_exp_f32 v87, v87
    v_exp_f32 v88, v88
    v_exp_f32 v89, v89
    v_exp_f32 v90, v90
    v_exp_f32 v91, v91
    v_smfmac_f32_32x32x32_bf16 v[180:195], v[168:171], v[80:87], v127
    v_exp_f32 v92, v92
    v_exp_f32 v93, v93
    v_exp_f32 v94, v94
    v_exp_f32 v95, v95
    s_waitcnt lgkmcnt(0)
    ds_read_b128 v[148:151], v125 offset:6368
    v_smfmac_f32_32x32x32_bf16 v[180:195], v[164:167], v[88:95], v127
    v_exp_f32 v96, v96
    v_exp_f32 v97, v97
    v_exp_f32 v98, v98
    v_exp_f32 v99, v99
    s_add_u32 m0, m0, 4096
    v_mfma_f32_32x32x16_bf16 v[48:63], v[156:159], v[32:35], v[48:63]
    buffer_load_dwordx4 v15, s[32:35], m0 offen sc1 lds
    v_exp_f32 v100, v100
    v_exp_f32 v101, v101
    v_exp_f32 v102, v102
    v_exp_f32 v103, v103
    v_mfma_f32_32x32x16_bf16 v[64:79], v[156:159], v[40:43], v[64:79]
    v_exp_f32 v104, v104
    v_exp_f32 v105, v105
    v_exp_f32 v106, v106
    v_exp_f32 v107, v107
    v_smfmac_f32_32x32x32_bf16 v[196:211], v[168:171], v[96:103], v127
    v_exp_f32 v108, v108
    v_exp_f32 v109, v109
    v_exp_f32 v110, v110
    v_exp_f32 v111, v111
    ds_read_b128 v[172:175], v124 offset:7104
    ds_read_b128 v[168:171], v125 offset:8128
    v_smfmac_f32_32x32x32_bf16 v[196:211], v[164:167], v[104:111], v127
    s_cbranch_vccz L_pr3
    s_setprio 2
L_pr3:
    v_exp_f32 v48, v48
    v_exp_f32 v49, v49
    v_exp_f32 v50, v50
    v_exp_f32 v51, v51
    s_add_u32 m0, m0, 4096
    v_mfma_f32_32x32x4_2b_bf16 v[80:111], v[176:177], v[46:47], 0
    buffer_load_dwordx4 v15, s[32:35], m0 offen sc1 lds
    ds_read_b32 v160, v126 offset:11712
    v_exp_f32 v52, v52
    v_exp_f32 v53, v53
    v_exp_f32 v54, v54
    v_exp_f32 v55, v55
    v_exp_f32 v56, v56
    v_exp_f32 v57, v57
    v_exp_f32 v58, v58
    v_exp_f32 v59, v59
    v_smfmac_f32_32x32x32_bf16 v[180:195], v[152:155], v[48:55], v127
    v_exp_f32 v60, v60
    v_exp_f32 v61, v61
    v_exp_f32 v62, v62
    v_exp_f32 v63, v63
    s_waitcnt lgkmcnt(0)
    ds_read_b128 v[164:167], v125 offset:8736
    v_smfmac_f32_32x32x32_bf16 v[180:195], v[148:151], v[56:63], v127
    v_exp_f32 v64, v64
    v_exp_f32 v65, v65
    v_exp_f32 v66, v66
    v_exp_f32 v67, v67
    s_add_u32 m0, m0, 4096
    v_mfma_f32_32x32x16_bf16 v[80:95], v[172:175], v[32:35], v[80:95]
    buffer_load_dwordx4 v15, s[32:35], m0 offen sc1 lds
    v_exp_f32 v68, v68
    v_exp_f32 v69, v69
    v_exp_f32 v70, v70
    v_exp_f32 v71, v71
    v_mfma_f32_32x32x16_bf16 v[96:111], v[172:175], v[40:43], v[96:111]
    v_exp_f32 v72, v72
    v_exp_f32 v73, v73
    v_exp_f32 v74, v74
    v_exp_f32 v75, v75
    v_smfmac_f32_32x32x32_bf16 v[196:211], v[152:155], v[64:71], v127
    v_exp_f32 v76, v76
    v_exp_f32 v77, v77
    v_exp_f32 v78, v78
    v_exp_f32 v79, v79
    ds_read_b128 v[156:159], v124 offset:9472
    ds_read_b128 v[152:155], v125 offset:10496
    v_smfmac_f32_32x32x32_bf16 v[196:211], v[148:151], v[72:79], v127
    v_exp_f32 v80, v80
    v_exp_f32 v81, v81
    v_exp_f32 v82, v82
    v_exp_f32 v83, v83
    s_add_u32 m0, m0, 4096
    v_mfma_f32_32x32x4_2b_bf16 v[48:79], v[160:161], v[46:47], 0
    buffer_load_dwordx4 v15, s[32:35], m0 offen sc1 lds
    ds_read_b32 v176, v126 offset:14080
    v_exp_f32 v84, v84
    v_exp_f32 v85, v85
    v_exp_f32 v86, v86
    v_exp_f32 v87, v87
    v_exp_f32 v88, v88
    v_exp_f32 v89, v89
    v_exp_f32 v90, v90
    v_exp_f32 v91, v91
    v_smfmac_f32_32x32x32_bf16 v[180:195], v[168:171], v[80:87], v127
    v_exp_f32 v92, v92
    v_exp_f32 v93, v93
    v_exp_f32 v94, v94
    v_exp_f32 v95, v95
    s_waitcnt lgkmcnt(0)
    ds_read_b128 v[148:151], v125 offset:11104
    v_smfmac_f32_32x32x32_bf16 v[180:195], v[164:167], v[88:95], v127
    v_exp_f32 v96, v96
    v_exp_f32 v97, v97
    v_exp_f32 v98, v98
    v_exp_f32 v99, v99
    s_add_u32 m0, m0, 4096
    v_mfma_f32_32x32x16_bf16 v[48:63], v[156:159], v[32:35], v[48:63]
    buffer_load_dwordx4 v15, s[32:35], m0 offen sc1 lds
    v_exp_f32 v100, v100
    v_exp_f32 v101, v101
    v_exp_f32 v102, v102
    v_exp_f32 v103, v103
    v_mfma_f32_32x32x16_bf16 v[64:79], v[156:159], v[40:43], v[64:79]
    v_exp_f32 v104, v104
    v_exp_f32 v105, v105
    v_exp_f32 v106, v106
    v_exp_f32 v107, v107
    v_smfmac_f32_32x32x32_bf16 v[196:211], v[168:171], v[96:103], v127
    v_exp_f32 v108, v108
    v_exp_f32 v109, v109
    v_exp_f32 v110, v110
    v_exp_f32 v111, v111
    ds_read_b128 v[172:175], v124 offset:11840
    ds_read_b128 v[168:171], v125 offset:12864
    v_smfmac_f32_32x32x32_bf16 v[196:211], v[164:167], v[104:111], v127
    v_exp_f32 v48, v48
    v_exp_f32 v49, v49
    v_exp_f32 v50, v50
    v_exp_f32 v51, v51
    s_add_u32 m0, m0, 4096
    v_mfma_f32_32x32x4_2b_bf16 v[80:111], v[176:177], v[46:47], 0
    buffer_load_dwordx4 v15, s[32:35], m0 offen sc1 lds
    ds_read_b32 v160, v126 offset:16448
    v_exp_f32 v52, v52
    v_exp_f32 v53, v53
    v_exp_f32 v54, v54
    v_exp_f32 v55, v55
    v_exp_f32 v56, v56
    v_exp_f32 v57, v57
    v_exp_f32 v58, v58
    v_exp_f32 v59, v59
    v_smfmac_f32_32x32x32_bf16 v[180:195], v[152:155], v[48:55], v127
    v_exp_f32 v60, v60
    v_exp_f32 v61, v61
    v_exp_f32 v62, v62
    v_exp_f32 v63, v63
    s_waitcnt lgkmcnt(0)
    ds_read_b128 v[164:167], v125 offset:13472
    v_smfmac_f32_32x32x32_bf16 v[180:195], v[148:151], v[56:63], v127
    v_exp_f32 v64, v64
    v_exp_f32 v65, v65
    v_exp_f32 v66, v66
    v_exp_f32 v67, v67
    s_add_u32 m0, m0, 4096
    v_mfma_f32_32x32x16_bf16 v[80:95], v[172:175], v[32:35], v[80:95]
    buffer_load_dwordx4 v15, s[32:35], m0 offen sc1 lds
    v_exp_f32 v68, v68
    v_exp_f32 v69, v69
    v_exp_f32 v70, v70
    v_exp_f32 v71, v71
    v_mfma_f32_32x32x16_bf16 v[96:111], v[172:175], v[40:43], v[96:111]
    v_exp_f32 v72, v72
    v_exp_f32 v73, v73
    v_exp_f32 v74, v74
    v_exp_f32 v75, v75
    v_smfmac_f32_32x32x32_bf16 v[196:211], v[152:155], v[64:71], v127
    v_exp_f32 v76, v76
    v_exp_f32 v77, v77
    v_exp_f32 v78, v78
    v_exp_f32 v79, v79
    ds_read_b128 v[156:159], v124 offset:14208
    ds_read_b128 v[152:155], v125 offset:15232
    v_smfmac_f32_32x32x32_bf16 v[196:211], v[148:151], v[72:79], v127
    s_cbranch_vccz L_pr4
    s_setprio 0
L_pr4:
    v_exp_f32 v80, v80
    v_exp_f32 v81, v81
    v_exp_f32 v82, v82
    v_exp_f32 v83, v83
    s_add_u32 m0, m0, 4096
    v_mfma_f32_32x32x4_2b_bf16 v[48:79], v[160:161], v[46:47], 0
    buffer_load_dwordx4 v15, s[32:35], m0 offen sc1 lds
    ds_read_b32 v176, v126 offset:18816
    v_exp_f32 v84, v84
    v_exp_f32 v85, v85
    v_exp_f32 v86, v86
    v_exp_f32 v87, v87
    v_exp_f32 v88, v88
    v_exp_f32 v89, v89
    v_exp_f32 v90, v90
    v_exp_f32 v91, v91
    v_smfmac_f32_32x32x32_bf16 v[180:195], v[168:171], v[80:87], v127
    v_exp_f32 v92, v92
    v_exp_f32 v93, v93
    v_exp_f32 v94, v94
    v_exp_f32 v95, v95
    s_waitcnt lgkmcnt(0)
    ds_read_b128 v[148:151], v125 offset:15840
    v_smfmac_f32_32x32x32_bf16 v[180:195], v[164:167], v[88:95], v127
    v_exp_f32 v96, v96
    v_exp_f32 v97, v97
    v_exp_f32 v98, v98
    v_exp_f32 v99, v99
    s_add_u32 m0, m0, 4096
    v_mfma_f32_32x32x16_bf16 v[48:63], v[156:159], v[32:35], v[48:63]
    buffer_load_dwordx4 v15, s[32:35], m0 offen sc1 lds
    v_exp_f32 v100, v100
    v_exp_f32 v101, v101
    v_exp_f32 v102, v102
    v_exp_f32 v103, v103
    v_mfma_f32_32x32x16_bf16 v[64:79], v[156:159], v[40:43], v[64:79]
    v_exp_f32 v104, v104
    v_exp_f32 v105, v105
    v_exp_f32 v106, v106
    v_exp_f32 v107, v107
    v_smfmac_f32_32x32x32_bf16 v[196:211], v[168:171], v[96:103], v127
    v_exp_f32 v108, v108
    v_exp_f32 v109, v109
    v_exp_f32 v110, v110
    v_exp_f32 v111, v111
    ds_read_b128 v[172:175], v124 offset:16576
    ds_read_b128 v[168:171], v125 offset:17600
    v_smfmac_f32_32x32x32_bf16 v[196:211], v[164:167], v[104:111], v127
    s_cbranch_vccz L_pr5
    s_setprio 2
L_pr5:
    v_exp_f32 v48, v48
    v_exp_f32 v49, v49
    v_exp_f32 v50, v50
    v_exp_f32 v51, v51
    v_mfma_f32_32x32x4_2b_bf16 v[80:111], v[176:177], v[46:47], 0
    ds_read_b32 v160, v126 offset:21184
    buffer_store_dwordx4 v[212:215], v15, s[36:39], s67 offen sc1
    s_mov_b32 exec_hi, 0
    buffer_store_dword v212, v15, s[36:39], s68 offen sc1
    s_mov_b32 exec_hi, -1
    v_exp_f32 v52, v52
    v_exp_f32 v53, v53
    v_exp_f32 v54, v54
    v_exp_f32 v55, v55
    v_exp_f32 v56, v56
    v_exp_f32 v57, v57
    v_exp_f32 v58, v58
    v_exp_f32 v59, v59
    v_smfmac_f32_32x32x32_bf16 v[180:195], v[152:155], v[48:55], v127
    v_exp_f32 v60, v60
    v_exp_f32 v61, v61
    v_exp_f32 v62, v62
    v_exp_f32 v63, v63
    s_waitcnt lgkmcnt(0)
    ds_read_b128 v[164:167], v125 offset:18208
    v_smfmac_f32_32x32x32_bf16 v[180:195], v[148:151], v[56:63], v127
    v_exp_f32 v64, v64
    v_exp_f32 v65, v65
    v_exp_f32 v66, v66
    v_exp_f32 v67, v67
    v_mfma_f32_32x32x16_bf16 v[80:95], v[172:175], v[32:35], v[80:95]
    v_exp_f32 v68, v68
    v_exp_f32 v69, v69
    v_exp_f32 v70, v70
    v_exp_f32 v71, v71
    v_mfma_f32_32x32x16_bf16 v[96:111], v[172:175], v[40:43], v[96:111]
    v_exp_f32 v72, v72
    v_exp_f32 v73, v73
    v_exp_f32 v74, v74
    v_exp_f32 v75, v75
    v_smfmac_f32_32x32x32_bf16 v[196:211], v[152:155], v[64:71], v127
    v_exp_f32 v76, v76
    v_exp_f32 v77, v77
    v_exp_f32 v78, v78
    v_exp_f32 v79, v79
    ds_read_b128 v[156:159], v124 offset:18944
    ds_read_b128 v[152:155], v125 offset:19968
    v_smfmac_f32_32x32x32_bf16 v[196:211], v[148:151], v[72:79], v127
    v_exp_f32 v80, v80
    v_exp_f32 v81, v81
    v_exp_f32 v82, v82
    v_exp_f32 v83, v83
    v_mfma_f32_32x32x4_2b_bf16 v[48:79], v[160:161], v[46:47], 0
    ds_read_b32 v176, v126 offset:23552
    v_exp_f32 v84, v84
    v_exp_f32 v85, v85
    v_exp_f32 v86, v86
    v_exp_f32 v87, v87
    v_exp_f32 v88, v88
    v_exp_f32 v89, v89
    v_exp_f32 v90, v90
    v_exp_f32 v91, v91
    v_smfmac_f32_32x32x32_bf16 v[180:195], v[168:171], v[80:87], v127
    v_exp_f32 v92, v92
    v_exp_f32 v93, v93
    v_exp_f32 v94, v94
    v_exp_f32 v95, v95
    s_waitcnt lgkmcnt(0)
    ds_read_b128 v[148:151], v125 offset:20576
    v_smfmac_f32_32x32x32_bf16 v[180:195], v[164:167], v[88:95], v127
    v_exp_f32 v96, v96
    v_exp_f32 v97, v97
    v_exp_f32 v98, v98
    v_exp_f32 v99, v99
    v_mfma_f32_32x32x16_bf16 v[48:63], v[156:159], v[32:35], v[48:63]
    v_exp_f32 v100, v100
    v_exp_f32 v101, v101
    v_exp_f32 v102, v102
    v_exp_f32 v103, v103
    v_mfma_f32_32x32x16_bf16 v[64:79], v[156:159], v[40:43], v[64:79]
    v_exp_f32 v104, v104
    v_exp_f32 v105, v105
    v_exp_f32 v106, v106
    v_exp_f32 v107, v107
    v_smfmac_f32_32x32x32_bf16 v[196:211], v[168:171], v[96:103], v127
    v_exp_f32 v108, v108
    v_exp_f32 v109, v109
    v_exp_f32 v110, v110
    v_exp_f32 v111, v111
    ds_read_b128 v[172:175], v124 offset:21312
    ds_read_b128 v[168:171], v125 offset:22336
    v_add_u32 v124, 18944, v124
    v_add_u32 v125, 18944, v125
    v_add_u32 v126, 18944, v126
.p2align 6
L_loop:
    v_smfmac_f32_32x32x32_bf16 v[196:211], v[164:167], v[104:111], v127
    v_exp_f32 v48, v48
    v_exp_f32 v49, v49
    v_exp_f32 v50, v50
    v_exp_f32 v51, v51
    v_mfma_f32_32x32x4_2b_bf16 v[80:111], v[176:177], v[46:47], 0
    ds_read_b32 v160, v126 offset:6976
    v_exp_f32 v52, v52
    v_exp_f32 v53, v53
    v_exp_f32 v54, v54
    v_exp_f32 v55, v55
    v_exp_f32 v56, v56
    v_exp_f32 v57, v57
    v_exp_f32 v58, v58
    v_exp_f32 v59, v59
    v_smfmac_f32_32x32x32_bf16 v[180:195], v[152:155], v[48:55], v127
    v_exp_f32 v60, v60
    v_exp_f32 v61, v61
    v_exp_f32 v62, v62
    v_exp_f32 v63, v63
    s_waitcnt lgkmcnt(0)
    ds_read_b128 v[164:167], v125 offset:4000
    v_smfmac_f32_32x32x32_bf16 v[180:195], v[148:151], v[56:63], v127
    v_exp_f32 v64, v64
    v_exp_f32 v65, v65
    v_exp_f32 v66, v66
    v_exp_f32 v67, v67
    v_mfma_f32_32x32x16_bf16 v[80:95], v[172:175], v[32:35], v[80:95]
    v_exp_f32 v68, v68
    v_exp_f32 v69, v69
    v_exp_f32 v70, v70
    v_exp_f32 v71, v71
    v_mfma_f32_32x32x16_bf16 v[96:111], v[172:175], v[40:43], v[96:111]
    v_exp_f32 v72, v72
    v_exp_f32 v73, v73
    v_exp_f32 v74, v74
    v_exp_f32 v75, v75
    v_smfmac_f32_32x32x32_bf16 v[196:211], v[152:155], v[64:71], v127
    v_exp_f32 v76, v76
    v_exp_f32 v77, v77
    v_exp_f32 v78, v78
    v_exp_f32 v79, v79
    ds_read_b128 v[156:159], v124 offset:4736
    ds_read_b128 v[152:155], v125 offset:5760
    v_smfmac_f32_32x32x32_bf16 v[196:211], v[148:151], v[72:79], v127
    s_cbranch_vccz L_pr6
    s_setprio 0
L_pr6:
    v_exp_f32 v80, v80
    v_exp_f32 v81, v81
    v_exp_f32 v82, v82
    v_exp_f32 v83, v83
    v_mfma_f32_32x32x4_2b_bf16 v[48:79], v[160:161], v[46:47], 0
    ds_read_b32 v176, v126 offset:9344
    v_exp_f32 v84, v84
    v_exp_f32 v85, v85
    v_exp_f32 v86, v86
    v_exp_f32 v87, v87
    v_exp_f32 v88, v88
    v_exp_f32 v89, v89
    v_exp_f32 v90, v90
    v_exp_f32 v91, v91
    v_smfmac_f32_32x32x32_bf16 v[180:195], v[168:171], v[80:87], v127
    v_exp_f32 v92, v92
    v_exp_f32 v93, v93
    v_exp_f32 v94, v94
    v_exp_f32 v95, v95
    s_waitcnt lgkmcnt(0)
    ds_read_b128 v[148:151], v125 offset:6368
    v_smfmac_f32_32x32x32_bf16 v[180:195], v[164:167], v[88:95], v127
    v_exp_f32 v96, v96
    v_exp_f32 v97, v97
    v_exp_f32 v98, v98
    v_exp_f32 v99, v99
    v_mfma_f32_32x32x16_bf16 v[48:63], v[156:159], v[32:35], v[48:63]
    v_exp_f32 v100, v100
    v_exp_f32 v101, v101
    v_exp_f32 v102, v102
    v_exp_f32 v103, v103
    v_mfma_f32_32x32x16_bf16 v[64:79], v[156:159], v[40:43], v[64:79]
    v_exp_f32 v104, v104
    v_exp_f32 v105, v105
    v_exp_f32 v106, v106
    v_exp_f32 v107, v107
    v_smfmac_f32_32x32x32_bf16 v[196:211], v[168:171], v[96:103], v127
    v_exp_f32 v108, v108
    v_exp_f32 v109, v109
    v_exp_f32 v110, v110
    v_exp_f32 v111, v111
    ds_read_b128 v[172:175], v124 offset:7104
    ds_read_b128 v[168:171], v125 offset:8128
    s_cmp_lg_u32 s66, 0
    s_cbranch_scc1 L_nobar
    s_waitcnt vmcnt(0)
    s_barrier
    s_cmp_lg_u32 s52, 0
    s_cbranch_scc1 L_nobar
    v_mov_b32 v4, s72
    v_mov_b32 v5, s73
    s_lshl_b32 s59, s54, 3
    v_mov_b32 v6, s59
    s_mov_b64 exec, 1
    buffer_store_dwordx2 v[4:5], v6, s[32:35], s84 offen sc1
    s_mov_b64 exec, -1
L_nobar:
    v_smfmac_f32_32x32x32_bf16 v[196:211], v[164:167], v[104:111], v127
    s_cbranch_vccz L_pr7
    s_setprio 2
L_pr7:
    v_exp_f32 v48, v48
    v_exp_f32 v49, v49
    v_exp_f32 v50, v50
    v_exp_f32 v51, v51
    v_mfma_f32_32x32x4_2b_bf16 v[80:111], v[176:177], v[46:47], 0
    ds_read_b32 v160, v126 offset:11712
    v_exp_f32 v52, v52
    v_exp_f32 v53, v53
    v_exp_f32 v54, v54
    v_exp_f32 v55, v55
    v_exp_f32 v56, v56
    v_exp_f32 v57, v57
    v_exp_f32 v58, v58
    v_exp_f32 v59, v59
    v_smfmac_f32_32x32x32_bf16 v[180:195], v[152:155], v[48:55], v127
    v_exp_f32 v60, v60
    v_exp_f32 v61, v61
    v_exp_f32 v62, v62
    v_exp_f32 v63, v63
    s_waitcnt lgkmcnt(0)
    ds_read_b128 v[164:167], v125 offset:8736
    v_smfmac_f32_32x32x32_bf16 v[180:195], v[148:151], v[56:63], v127
    v_exp_f32 v64, v64
    v_exp_f32 v65, v65
    v_exp_f32 v66, v66
    v_exp_f32 v67, v67
    v_mfma_f32_32x32x16_bf16 v[80:95], v[172:175], v[32:35], v[80:95]
    v_exp_f32 v68, v68
    v_exp_f32 v69, v69
    v_exp_f32 v70, v70
    v_exp_f32 v71, v71
    v_mfma_f32_32x32x16_bf16 v[96:111], v[172:175], v[40:43], v[96:111]
    v_exp_f32 v72, v72
    v_exp_f32 v73, v73
    v_exp_f32 v74, v74
    v_exp_f32 v75, v75
    v_smfmac_f32_32x32x32_bf16 v[196:211], v[152:155], v[64:71], v127
    v_exp_f32 v76, v76
    v_exp_f32 v77, v77
    v_exp_f32 v78, v78
    v_exp_f32 v79, v79
    ds_read_b128 v[156:159], v124 offset:9472
    ds_read_b128 v[152:155], v125 offset:10496
    v_smfmac_f32_32x32x32_bf16 v[196:211], v[148:151], v[72:79], v127
    v_exp_f32 v80, v80
    v_exp_f32 v81, v81
    v_exp_f32 v82, v82
    v_exp_f32 v83, v83
    v_mfma_f32_32x32x4_2b_bf16 v[48:79], v[160:161], v[46:47], 0
    ds_read_b32 v176, v126 offset:14080
    v_exp_f32 v84, v84
    v_exp_f32 v85, v85
    v_exp_f32 v86, v86
    v_exp_f32 v87, v87
    v_exp_f32 v88, v88
    v_exp_f32 v89, v89
    v_exp_f32 v90, v90
    v_exp_f32 v91, v91
    v_smfmac_f32_32x32x32_bf16 v[180:195], v[168:171], v[80:87], v127
    v_exp_f32 v92, v92
    v_exp_f32 v93, v93
    v_exp_f32 v94, v94
    v_exp_f32 v95, v95
    s_waitcnt lgkmcnt(0)
    ds_read_b128 v[148:151], v125 offset:11104
    v_smfmac_f32_32x32x32_bf16 v[180:195], v[164:167], v[88:95], v127
    v_exp_f32 v96, v96
    v_exp_f32 v97, v97
    v_exp_f32 v98, v98
    v_exp_f32 v99, v99
    v_mfma_f32_32x32x16_bf16 v[48:63], v[156:159], v[32:35], v[48:63]
    v_exp_f32 v100, v100
    v_exp_f32 v101, v101
    v_exp_f32 v102, v102
    v_exp_f32 v103, v103
    v_mfma_f32_32x32x16_bf16 v[64:79], v[156:159], v[40:43], v[64:79]
    v_exp_f32 v104, v104
    v_exp_f32 v105, v105
    v_exp_f32 v106, v106
    v_exp_f32 v107, v107
    v_smfmac_f32_32x32x32_bf16 v[196:211], v[168:171], v[96:103], v127
    v_exp_f32 v108, v108
    v_exp_f32 v109, v109
    v_exp_f32 v110, v110
    v_exp_f32 v111, v111
    ds_read_b128 v[172:175], v124 offset:11840
    ds_read_b128 v[168:171], v125 offset:12864
    v_smfmac_f32_32x32x32_bf16 v[196:211], v[164:167], v[104:111], v127
    v_exp_f32 v48, v48
    v_exp_f32 v49, v49
    v_exp_f32 v50, v50
    v_exp_f32 v51, v51
    v_mfma_f32_32x32x4_2b_bf16 v[80:111], v[176:177], v[46:47], 0
    ds_read_b32 v160, v126 offset:16448
    v_exp_f32 v52, v52
    v_exp_f32 v53, v53
    v_exp_f32 v54, v54
    v_exp_f32 v55, v55
    v_exp_f32 v56, v56
    v_exp_f32 v57, v57
    v_exp_f32 v58, v58
    v_exp_f32 v59, v59
    v_smfmac_f32_32x32x32_bf16 v[180:195], v[152:155], v[48:55], v127
    v_exp_f32 v60, v60
    v_exp_f32 v61, v61
    v_exp_f32 v62, v62
    v_exp_f32 v63, v63
    s_waitcnt lgkmcnt(0)
    ds_read_b128 v[164:167], v125 offset:13472
    v_smfmac_f32_32x32x32_bf16 v[180:195], v[148:151], v[56:63], v127
    v_exp_f32 v64, v64
    v_exp_f32 v65, v65
    v_exp_f32 v66, v66
    v_exp_f32 v67, v67
    v_mfma_f32_32x32x16_bf16 v[80:95], v[172:175], v[32:35], v[80:95]
    v_exp_f32 v68, v68
    v_exp_f32 v69, v69
    v_exp_f32 v70, v70
    v_exp_f32 v71, v71
    v_mfma_f32_32x32x16_bf16 v[96:111], v[172:175], v[40:43], v[96:111]
    v_exp_f32 v72, v72
    v_exp_f32 v73, v73
    v_exp_f32 v74, v74
    v_exp_f32 v75, v75
    v_smfmac_f32_32x32x32_bf16 v[196:211], v[152:155], v[64:71], v127
    v_exp_f32 v76, v76
    v_exp_f32 v77, v77
    v_exp_f32 v78, v78
    v_exp_f32 v79, v79
    ds_read_b128 v[156:159], v124 offset:14208
    ds_read_b128 v[152:155], v125 offset:15232
    v_smfmac_f32_32x32x32_bf16 v[196:211], v[148:151], v[72:79], v127
    s_cbranch_vccz L_pr8
    s_setprio 0
L_pr8:
    v_exp_f32 v80, v80
    v_exp_f32 v81, v81
    v_exp_f32 v82, v82
    v_exp_f32 v83, v83
    v_mfma_f32_32x32x4_2b_bf16 v[48:79], v[160:161], v[46:47], 0
    ds_read_b32 v176, v126 offset:18816
    v_exp_f32 v84, v84
    v_exp_f32 v85, v85
    v_exp_f32 v86, v86
    v_exp_f32 v87, v87
    v_exp_f32 v88, v88
    v_exp_f32 v89, v89
    v_exp_f32 v90, v90
    v_exp_f32 v91, v91
    v_smfmac_f32_32x32x32_bf16 v[180:195], v[168:171], v[80:87], v127
    v_exp_f32 v92, v92
    v_exp_f32 v93, v93
    v_exp_f32 v94, v94
    v_exp_f32 v95, v95
    s_waitcnt lgkmcnt(0)
    ds_read_b128 v[148:151], v125 offset:15840
    v_smfmac_f32_32x32x32_bf16 v[180:195], v[164:167], v[88:95], v127
    v_exp_f32 v96, v96
    v_exp_f32 v97, v97
    v_exp_f32 v98, v98
    v_exp_f32 v99, v99
    v_mfma_f32_32x32x16_bf16 v[48:63], v[156:159], v[32:35], v[48:63]
    v_exp_f32 v100, v100
    v_exp_f32 v101, v101
    v_exp_f32 v102, v102
    v_exp_f32 v103, v103
    v_mfma_f32_32x32x16_bf16 v[64:79], v[156:159], v[40:43], v[64:79]
    v_exp_f32 v104, v104
    v_exp_f32 v105, v105
    v_exp_f32 v106, v106
    v_exp_f32 v107, v107
    v_smfmac_f32_32x32x32_bf16 v[196:211], v[168:171], v[96:103], v127
    v_exp_f32 v108, v108
    v_exp_f32 v109, v109
    v_exp_f32 v110, v110
    v_exp_f32 v111, v111
    ds_read_b128 v[172:175], v124 offset:16576
    ds_read_b128 v[168:171], v125 offset:17600
    v_smfmac_f32_32x32x32_bf16 v[196:211], v[164:167], v[104:111], v127
    s_cbranch_vccz L_pr9
    s_setprio 2
L_pr9:
    v_exp_f32 v48, v48
    v_exp_f32 v49, v49
    v_exp_f32 v50, v50
    v_exp_f32 v51, v51
    v_mfma_f32_32x32x4_2b_bf16 v[80:111], v[176:177], v[46:47], 0
    ds_read_b32 v160, v126 offset:21184
    v_exp_f32 v52, v52
    v_exp_f32 v53, v53
    v_exp_f32 v54, v54
    v_exp_f32 v55, v55
    v_exp_f32 v56, v56
    v_exp_f32 v57, v57
    v_exp_f32 v58, v58
    v_exp_f32 v59, v59
    v_smfmac_f32_32x32x32_bf16 v[180:195], v[152:155], v[48:55], v127
    v_exp_f32 v60, v60
    v_exp_f32 v61, v61
    v_exp_f32 v62, v62
    v_exp_f32 v63, v63
    s_waitcnt lgkmcnt(0)
    ds_read_b128 v[164:167], v125 offset:18208
    v_smfmac_f32_32x32x32_bf16 v[180:195], v[148:151], v[56:63], v127
    v_exp_f32 v64, v64
    v_exp_f32 v65, v65
    v_exp_f32 v66, v66
    v_exp_f32 v67, v67
    v_mfma_f32_32x32x16_bf16 v[80:95], v[172:175], v[32:35], v[80:95]
    v_exp_f32 v68, v68
    v_exp_f32 v69, v69
    v_exp_f32 v70, v70
    v_exp_f32 v71, v71
    v_mfma_f32_32x32x16_bf16 v[96:111], v[172:175], v[40:43], v[96:111]
    v_exp_f32 v72, v72
    v_exp_f32 v73, v73
    v_exp_f32 v74, v74
    v_exp_f32 v75, v75
    v_smfmac_f32_32x32x32_bf16 v[196:211], v[152:155], v[64:71], v127
    v_exp_f32 v76, v76
    v_exp_f32 v77, v77
    v_exp_f32 v78, v78
    v_exp_f32 v79, v79
    ds_read_b128 v[156:159], v124 offset:18944
    ds_read_b128 v[152:155], v125 offset:19968
    v_smfmac_f32_32x32x32_bf16 v[196:211], v[148:151], v[72:79], v127
    v_exp_f32 v80, v80
    v_exp_f32 v81, v81
    v_exp_f32 v82, v82
    v_exp_f32 v83, v83
    v_mfma_f32_32x32x4_2b_bf16 v[48:79], v[160:161], v[46:47], 0
    ds_read_b32 v176, v126 offset:23552
    v_exp_f32 v84, v84
    v_exp_f32 v85, v85
    v_exp_f32 v86, v86
    v_exp_f32 v87, v87
    v_exp_f32 v88, v88
    v_exp_f32 v89, v89
    v_exp_f32 v90, v90
    v_exp_f32 v91, v91
    v_smfmac_f32_32x32x32_bf16 v[180:195], v[168:171], v[80:87], v127
    v_exp_f32 v92, v92
    v_exp_f32 v93, v93
    v_exp_f32 v94, v94
    v_exp_f32 v95, v95
    s_waitcnt lgkmcnt(0)
    ds_read_b128 v[148:151], v125 offset:20576
    v_smfmac_f32_32x32x32_bf16 v[180:195], v[164:167], v[88:95], v127
    v_exp_f32 v96, v96
    v_exp_f32 v97, v97
    v_exp_f32 v98, v98
    v_exp_f32 v99, v99
    v_mfma_f32_32x32x16_bf16 v[48:63], v[156:159], v[32:35], v[48:63]
    v_exp_f32 v100, v100
    v_exp_f32 v101, v101
    v_exp_f32 v102, v102
    v_exp_f32 v103, v103
    v_mfma_f32_32x32x16_bf16 v[64:79], v[156:159], v[40:43], v[64:79]
    v_exp_f32 v104, v104
    v_exp_f32 v105, v105
    v_exp_f32 v106, v106
    v_exp_f32 v107, v107
    v_smfmac_f32_32x32x32_bf16 v[196:211], v[168:171], v[96:103], v127
    v_exp_f32 v108, v108
    v_exp_f32 v109, v109
    v_exp_f32 v110, v110
    v_exp_f32 v111, v111
    ds_read_b128 v[172:175], v124 offset:21312
    ds_read_b128 v[168:171], v125 offset:22336
    v_add_u32 v124, 18944, v124
    v_add_u32 v125, 18944, v125
    v_add_u32 v126, 18944, v126
    s_add_u32 s66, s66, 1
    s_cmp_lt_u32 s66, 2
    s_cbranch_scc1 L_loop
    s_waitcnt vmcnt(0)
    s_barrier
    buffer_load_dwordx2 v[216:217], v178, s[32:35], s84 offen sc1
    v_smfmac_f32_32x32x32_bf16 v[196:211], v[164:167], v[104:111], v127
    v_exp_f32 v48, v48
    v_exp_f32 v49, v49
    v_exp_f32 v50, v50
    v_exp_f32 v51, v51
    v_mfma_f32_32x32x4_2b_bf16 v[80:111], v[176:177], v[46:47], 0
    ds_read_b32 v160, v126 offset:6976
    s_add_u32 m0, s85, 0
    s_add_u32 s63, s86, 0
    buffer_load_dwordx4 v128, s[40:43], s63 offen lds
    v_exp_f32 v52, v52
    v_exp_f32 v53, v53
    v_exp_f32 v54, v54
    v_exp_f32 v55, v55
    v_exp_f32 v56, v56
    v_exp_f32 v57, v57
    v_exp_f32 v58, v58
    v_exp_f32 v59, v59
    v_smfmac_f32_32x32x32_bf16 v[180:195], v[152:155], v[48:55], v127
    v_exp_f32 v60, v60
    v_exp_f32 v61, v61
    v_exp_f32 v62, v62
    v_exp_f32 v63, v63
    s_waitcnt lgkmcnt(0)
    ds_read_b128 v[164:167], v125 offset:4000
    v_smfmac_f32_32x32x32_bf16 v[180:195], v[148:151], v[56:63], v127
    v_exp_f32 v64, v64
    v_exp_f32 v65, v65
    v_exp_f32 v66, v66
    v_exp_f32 v67, v67
    v_mfma_f32_32x32x16_bf16 v[80:95], v[172:175], v[32:35], v[80:95]
    s_add_u32 m0, s85, 7680
    s_add_u32 s63, s86, 55296
    buffer_load_dwordx4 v128, s[40:43], s63 offen lds
    v_exp_f32 v68, v68
    v_exp_f32 v69, v69
    v_exp_f32 v70, v70
    v_exp_f32 v71, v71
    v_mfma_f32_32x32x16_bf16 v[96:111], v[172:175], v[40:43], v[96:111]
    v_exp_f32 v72, v72
    v_exp_f32 v73, v73
    v_exp_f32 v74, v74
    v_exp_f32 v75, v75
    v_smfmac_f32_32x32x32_bf16 v[196:211], v[152:155], v[64:71], v127
    v_exp_f32 v76, v76
    v_exp_f32 v77, v77
    v_exp_f32 v78, v78
    v_exp_f32 v79, v79
    ds_read_b128 v[156:159], v124 offset:4736
    ds_read_b128 v[152:155], v125 offset:5760
    v_smfmac_f32_32x32x32_bf16 v[196:211], v[148:151], v[72:79], v127
    s_cbranch_vccz L_pr10
    s_setprio 0
L_pr10:
    v_exp_f32 v80, v80
    v_exp_f32 v81, v81
    v_exp_f32 v82, v82
    v_exp_f32 v83, v83
    v_mfma_f32_32x32x4_2b_bf16 v[48:79], v[160:161], v[46:47], 0
    ds_read_b32 v176, v126 offset:9344
    s_add_u32 m0, s85, 15360
    s_add_u32 s63, s86, 110592
    buffer_load_dwordx4 v128, s[40:43], s63 offen lds
    v_exp_f32 v84, v84
    v_exp_f32 v85, v85
    v_exp_f32 v86, v86
    v_exp_f32 v87, v87
    v_exp_f32 v88, v88
    v_exp_f32 v89, v89
    v_exp_f32 v90, v90
    v_exp_f32 v91, v91
    v_smfmac_f32_32x32x32_bf16 v[180:195], v[168:171], v[80:87], v127
    v_exp_f32 v92, v92
    v_exp_f32 v93, v93
    v_exp_f32 v94, v94
    v_exp_f32 v95, v95
    s_waitcnt lgkmcnt(0)
    ds_read_b128 v[148:151], v125 offset:6368
    v_smfmac_f32_32x32x32_bf16 v[180:195], v[164:167], v[88:95], v127
    v_exp_f32 v96, v96
    v_exp_f32 v97, v97
    v_exp_f32 v98, v98
    v_exp_f32 v99, v99
    v_mfma_f32_32x32x16_bf16 v[48:63], v[156:159], v[32:35], v[48:63]
    s_add_u32 m0, s85, 23040
    s_add_u32 s63, s86, 165888
    buffer_load_dwordx4 v128, s[40:43], s63 offen lds
    v_exp_f32 v100, v100
    v_exp_f32 v101, v101
    v_exp_f32 v102, v102
    v_exp_f32 v103, v103
    v_mfma_f32_32x32x16_bf16 v[64:79], v[156:159], v[40:43], v[64:79]
    v_exp_f32 v104, v104
    v_exp_f32 v105, v105
    v_exp_f32 v106, v106
    v_exp_f32 v107, v107
    v_smfmac_f32_32x32x32_bf16 v[196:211], v[168:171], v[96:103], v127
    v_exp_f32 v108, v108
    v_exp_f32 v109, v109
    v_exp_f32 v110, v110
    v_exp_f32 v111, v111
    ds_read_b128 v[172:175], v124 offset:7104
    ds_read_b128 v[168:171], v125 offset:8128
    v_smfmac_f32_32x32x32_bf16 v[196:211], v[164:167], v[104:111], v127
    s_cbranch_vccz L_pr11
    s_setprio 2
L_pr11:
    v_exp_f32 v48, v48
    v_exp_f32 v49, v49
    v_exp_f32 v50, v50
    v_exp_f32 v51, v51
    v_mfma_f32_32x32x4_2b_bf16 v[80:111], v[176:177], v[46:47], 0
    ds_read_b32 v160, v126 offset:11712
    s_add_u32 m0, s85, 30720
    s_add_u32 s63, s86, 221184
    buffer_load_dwordx4 v128, s[40:43], s63 offen lds
    v_exp_f32 v52, v52
    v_exp_f32 v53, v53
    v_exp_f32 v54, v54
    v_exp_f32 v55, v55
    v_exp_f32 v56, v56
    v_exp_f32 v57, v57
    v_exp_f32 v58, v58
    v_exp_f32 v59, v59
    v_smfmac_f32_32x32x32_bf16 v[180:195], v[152:155], v[48:55], v127
    v_exp_f32 v60, v60
    v_exp_f32 v61, v61
    v_exp_f32 v62, v62
    v_exp_f32 v63, v63
    s_waitcnt lgkmcnt(0)
    ds_read_b128 v[164:167], v125 offset:8736
    v_smfmac_f32_32x32x32_bf16 v[180:195], v[148:151], v[56:63], v127
    v_exp_f32 v64, v64
    v_exp_f32 v65, v65
    v_exp_f32 v66, v66
    v_exp_f32 v67, v67
    v_mfma_f32_32x32x16_bf16 v[80:95], v[172:175], v[32:35], v[80:95]
    s_add_u32 m0, s85, 38400
    s_add_u32 s63, s86, 276480
    buffer_load_dwordx4 v128, s[40:43], s63 offen lds
    v_exp_f32 v68, v68
    v_exp_f32 v69, v69
    v_exp_f32 v70, v70
    v_exp_f32 v71, v71
    v_mfma_f32_32x32x16_bf16 v[96:111], v[172:175], v[40:43], v[96:111]
    v_exp_f32 v72, v72
    v_exp_f32 v73, v73
    v_exp_f32 v74, v74
    v_exp_f32 v75, v75
    v_smfmac_f32_32x32x32_bf16 v[196:211], v[152:155], v[64:71], v127
    v_exp_f32 v76, v76
    v_exp_f32 v77, v77
    v_exp_f32 v78, v78
    v_exp_f32 v79, v79
    ds_read_b128 v[156:159], v124 offset:9472
    ds_read_b128 v[152:155], v125 offset:10496
    v_smfmac_f32_32x32x32_bf16 v[196:211], v[148:151], v[72:79], v127
    v_exp_f32 v80, v80
    v_exp_f32 v81, v81
    v_exp_f32 v82, v82
    v_exp_f32 v83, v83
    v_mfma_f32_32x32x4_2b_bf16 v[48:79], v[160:161], v[46:47], 0
    ds_read_b32 v176, v126 offset:14080
    s_add_u32 m0, s85, 75776
    s_add_u32 s63, s86, 331776
    buffer_load_dwordx4 v128, s[40:43], s63 offen lds
    v_exp_f32 v84, v84
    v_exp_f32 v85, v85
    v_exp_f32 v86, v86
    v_exp_f32 v87, v87
    v_exp_f32 v88, v88
    v_exp_f32 v89, v89
    v_exp_f32 v90, v90
    v_exp_f32 v91, v91
    v_smfmac_f32_32x32x32_bf16 v[180:195], v[168:171], v[80:87], v127
    v_exp_f32 v92, v92
    v_exp_f32 v93, v93
    v_exp_f32 v94, v94
    v_exp_f32 v95, v95
    s_waitcnt lgkmcnt(0)
    ds_read_b128 v[148:151], v125 offset:11104
    v_smfmac_f32_32x32x32_bf16 v[180:195], v[164:167], v[88:95], v127
    v_exp_f32 v96, v96
    v_exp_f32 v97, v97
    v_exp_f32 v98, v98
    v_exp_f32 v99, v99
    v_mfma_f32_32x32x16_bf16 v[48:63], v[156:159], v[32:35], v[48:63]
    s_add_u32 m0, s85, 83456
    s_add_u32 s63, s86, 387072
    buffer_load_dwordx4 v128, s[40:43], s63 offen lds
    v_exp_f32 v100, v100
    v_exp_f32 v101, v101
    v_exp_f32 v102, v102
    v_exp_f32 v103, v103
    v_mfma_f32_32x32x16_bf16 v[64:79], v[156:159], v[40:43], v[64:79]
    v_exp_f32 v104, v104
    v_exp_f32 v105, v105
    v_exp_f32 v106, v106
    v_exp_f32 v107, v107
    v_smfmac_f32_32x32x32_bf16 v[196:211], v[168:171], v[96:103], v127
    v_exp_f32 v108, v108
    v_exp_f32 v109, v109
    v_exp_f32 v110, v110
    v_exp_f32 v111, v111
    ds_read_b128 v[172:175], v124 offset:11840
    ds_read_b128 v[168:171], v125 offset:12864
    v_smfmac_f32_32x32x32_bf16 v[196:211], v[164:167], v[104:111], v127
    v_exp_f32 v48, v48
    v_exp_f32 v49, v49
    v_exp_f32 v50, v50
    v_exp_f32 v51, v51
    v_mfma_f32_32x32x4_2b_bf16 v[80:111], v[176:177], v[46:47], 0
    ds_read_b32 v160, v126 offset:16448
    s_add_u32 m0, s85, 91136
    s_add_u32 s63, s86, 442368
    buffer_load_dwordx4 v128, s[40:43], s63 offen lds
    v_exp_f32 v52, v52
    v_exp_f32 v53, v53
    v_exp_f32 v54, v54
    v_exp_f32 v55, v55
    v_exp_f32 v56, v56
    v_exp_f32 v57, v57
    v_exp_f32 v58, v58
    v_exp_f32 v59, v59
    v_smfmac_f32_32x32x32_bf16 v[180:195], v[152:155], v[48:55], v127
    v_exp_f32 v60, v60
    v_exp_f32 v61, v61
    v_exp_f32 v62, v62
    v_exp_f32 v63, v63
    s_waitcnt lgkmcnt(0)
    ds_read_b128 v[164:167], v125 offset:13472
    v_smfmac_f32_32x32x32_bf16 v[180:195], v[148:151], v[56:63], v127
    v_exp_f32 v64, v64
    v_exp_f32 v65, v65
    v_exp_f32 v66, v66
    v_exp_f32 v67, v67
    v_mfma_f32_32x32x16_bf16 v[80:95], v[172:175], v[32:35], v[80:95]
    s_add_u32 m0, s85, 98816
    s_add_u32 s63, s86, 497664
    buffer_load_dwordx4 v128, s[40:43], s63 offen lds
    v_exp_f32 v68, v68
    v_exp_f32 v69, v69
    v_exp_f32 v70, v70
    v_exp_f32 v71, v71
    v_mfma_f32_32x32x16_bf16 v[96:111], v[172:175], v[40:43], v[96:111]
    v_exp_f32 v72, v72
    v_exp_f32 v73, v73
    v_exp_f32 v74, v74
    v_exp_f32 v75, v75
    v_smfmac_f32_32x32x32_bf16 v[196:211], v[152:155], v[64:71], v127
    v_exp_f32 v76, v76
    v_exp_f32 v77, v77
    v_exp_f32 v78, v78
    v_exp_f32 v79, v79
    ds_read_b128 v[156:159], v124 offset:14208
    ds_read_b128 v[152:155], v125 offset:15232
    v_smfmac_f32_32x32x32_bf16 v[196:211], v[148:151], v[72:79], v127
    s_cbranch_vccz L_pr12
    s_setprio 0
L_pr12:
    v_exp_f32 v80, v80
    v_exp_f32 v81, v81
    v_exp_f32 v82, v82
    v_exp_f32 v83, v83
    v_mfma_f32_32x32x4_2b_bf16 v[48:79], v[160:161], v[46:47], 0
    ds_read_b32 v176, v126 offset:18816
    s_add_u32 m0, s85, 106496
    s_add_u32 s63, s86, 552960
    buffer_load_dwordx4 v128, s[40:43], s63 offen lds
    v_exp_f32 v84, v84
    v_exp_f32 v85, v85
    v_exp_f32 v86, v86
    v_exp_f32 v87, v87
    v_exp_f32 v88, v88
    v_exp_f32 v89, v89
    v_exp_f32 v90, v90
    v_exp_f32 v91, v91
    v_smfmac_f32_32x32x32_bf16 v[180:195], v[168:171], v[80:87], v127
    v_exp_f32 v92, v92
    v_exp_f32 v93, v93
    v_exp_f32 v94, v94
    v_exp_f32 v95, v95
    s_waitcnt lgkmcnt(0)
    ds_read_b128 v[148:151], v125 offset:15840
    v_smfmac_f32_32x32x32_bf16 v[180:195], v[164:167], v[88:95], v127
    v_exp_f32 v96, v96
    v_exp_f32 v97, v97
    v_exp_f32 v98, v98
    v_exp_f32 v99, v99
    v_mfma_f32_32x32x16_bf16 v[48:63], v[156:159], v[32:35], v[48:63]
    s_add_u32 m0, s85, 114176
    s_add_u32 s63, s86, 608256
    buffer_load_dwordx4 v128, s[40:43], s63 offen lds
    v_exp_f32 v100, v100
    v_exp_f32 v101, v101
    v_exp_f32 v102, v102
    v_exp_f32 v103, v103
    v_mfma_f32_32x32x16_bf16 v[64:79], v[156:159], v[40:43], v[64:79]
    v_exp_f32 v104, v104
    v_exp_f32 v105, v105
    v_exp_f32 v106, v106
    v_exp_f32 v107, v107
    v_smfmac_f32_32x32x32_bf16 v[196:211], v[168:171], v[96:103], v127
    v_exp_f32 v108, v108
    v_exp_f32 v109, v109
    v_exp_f32 v110, v110
    v_exp_f32 v111, v111
    ds_read_b128 v[172:175], v124 offset:16576
    ds_read_b128 v[168:171], v125 offset:17600
    v_smfmac_f32_32x32x32_bf16 v[196:211], v[164:167], v[104:111], v127
    s_cbranch_vccz L_pr13
    s_setprio 2
L_pr13:
    v_exp_f32 v48, v48
    v_exp_f32 v49, v49
    v_exp_f32 v50, v50
    v_exp_f32 v51, v51
    v_mfma_f32_32x32x4_2b_bf16 v[80:111], v[176:177], v[46:47], 0
    ds_read_b32 v160, v126 offset:21184
    v_exp_f32 v52, v52
    v_exp_f32 v53, v53
    v_exp_f32 v54, v54
    v_exp_f32 v55, v55
    v_exp_f32 v56, v56
    v_exp_f32 v57, v57
    v_exp_f32 v58, v58
    v_exp_f32 v59, v59
    v_smfmac_f32_32x32x32_bf16 v[180:195], v[152:155], v[48:55], v127
    v_exp_f32 v60, v60
    v_exp_f32 v61, v61
    v_exp_f32 v62, v62
    v_exp_f32 v63, v63
    s_waitcnt lgkmcnt(0)
    ds_read_b128 v[164:167], v125 offset:18208
    v_smfmac_f32_32x32x32_bf16 v[180:195], v[148:151], v[56:63], v127
    v_exp_f32 v64, v64
    v_exp_f32 v65, v65
    v_exp_f32 v66, v66
    v_exp_f32 v67, v67
    v_mfma_f32_32x32x16_bf16 v[80:95], v[172:175], v[32:35], v[80:95]
    v_exp_f32 v68, v68
    v_exp_f32 v69, v69
    v_exp_f32 v70, v70
    v_exp_f32 v71, v71
    v_mfma_f32_32x32x16_bf16 v[96:111], v[172:175], v[40:43], v[96:111]
    v_exp_f32 v72, v72
    v_exp_f32 v73, v73
    v_exp_f32 v74, v74
    v_exp_f32 v75, v75
    v_smfmac_f32_32x32x32_bf16 v[196:211], v[152:155], v[64:71], v127
    v_exp_f32 v76, v76
    v_exp_f32 v77, v77
    v_exp_f32 v78, v78
    v_exp_f32 v79, v79
    ds_read_b128 v[156:159], v124 offset:18944
    ds_read_b128 v[152:155], v125 offset:19968
    v_smfmac_f32_32x32x32_bf16 v[196:211], v[148:151], v[72:79], v127
    v_exp_f32 v80, v80
    v_exp_f32 v81, v81
    v_exp_f32 v82, v82
    v_exp_f32 v83, v83
    v_mfma_f32_32x32x4_2b_bf16 v[48:79], v[160:161], v[46:47], 0
    ds_read_b32 v176, v126 offset:23552
    v_exp_f32 v84, v84
    v_exp_f32 v85, v85
    v_exp_f32 v86, v86
    v_exp_f32 v87, v87
    v_exp_f32 v88, v88
    v_exp_f32 v89, v89
    v_exp_f32 v90, v90
    v_exp_f32 v91, v91
    v_smfmac_f32_32x32x32_bf16 v[180:195], v[168:171], v[80:87], v127
    v_exp_f32 v92, v92
    v_exp_f32 v93, v93
    v_exp_f32 v94, v94
    v_exp_f32 v95, v95
    s_waitcnt lgkmcnt(0)
    ds_read_b128 v[148:151], v125 offset:20576
    v_smfmac_f32_32x32x32_bf16 v[180:195], v[164:167], v[88:95], v127
    v_exp_f32 v96, v96
    v_exp_f32 v97, v97
    v_exp_f32 v98, v98
    v_exp_f32 v99, v99
    v_mfma_f32_32x32x16_bf16 v[48:63], v[156:159], v[32:35], v[48:63]
    v_exp_f32 v100, v100
    v_exp_f32 v101, v101
    v_exp_f32 v102, v102
    v_exp_f32 v103, v103
    v_mfma_f32_32x32x16_bf16 v[64:79], v[156:159], v[40:43], v[64:79]
    v_exp_f32 v104, v104
    v_exp_f32 v105, v105
    v_exp_f32 v106, v106
    v_exp_f32 v107, v107
    v_smfmac_f32_32x32x32_bf16 v[196:211], v[168:171], v[96:103], v127
    v_exp_f32 v108, v108
    v_exp_f32 v109, v109
    v_exp_f32 v110, v110
    v_exp_f32 v111, v111
    ds_read_b128 v[172:175], v124 offset:21312
    ds_read_b128 v[168:171], v125 offset:22336
    v_smfmac_f32_32x32x32_bf16 v[196:211], v[164:167], v[104:111], v127
    s_setprio 0
    s_mov_b32 s59, 0x2f800000
    s_mov_b32 s60, 0x5f800000
    s_mov_b32 s63, 0x7f800000
    s_mov_b32 s66, 0
    s_nop 0
    s_cmp_eq_u32 s58, 1
    s_cbranch_scc1 L_send0
    s_nop 4
    ds_write_b128 v134, v[196:199]
    ds_write_b128 v134, v[200:203] offset:1024
    s_mov_b32 exec_hi, 0
    ds_write_b128 v134, v[204:207] offset:2048
    s_mov_b32 exec_hi, -1
    s_waitcnt vmcnt(0)
L_f20:
    v_xor_b32 v216, s72, v216
    v_xor_b32 v217, s73, v217
    v_or_b32 v2, v216, v217
    v_cmp_ne_u32 vcc, 0, v2
    s_cbranch_vccnz L_f2retry0
L_f2ok0:
    s_mov_b32 s66, 0
    s_waitcnt lgkmcnt(0)
    s_barrier
    ds_read_b128 v[48:51], v135 offset:0
    ds_read_b128 v[52:55], v135 offset:1024
    ds_read_b128 v[56:59], v135 offset:2048
    ds_read_b64_tr_b16 v[80:81], v136 offset:0
    ds_read_b64_tr_b16 v[82:83], v137 offset:0
    ds_read_b64_tr_b16 v[84:85], v136 offset:32
    ds_read_b64_tr_b16 v[86:87], v137 offset:32
    s_waitcnt lgkmcnt(5)
    v_pk_add_f32 v[180:181], v[180:181], v[48:49]
    v_pk_add_f32 v[182:183], v[182:183], v[50:51]
    v_pk_add_f32 v[184:185], v[184:185], v[52:53]
    v_pk_add_f32 v[186:187], v[186:187], v[54:55]
    s_waitcnt lgkmcnt(4)
    s_mov_b32 exec_hi, 0
    v_pk_add_f32 v[188:189], v[188:189], v[56:57]
    v_pk_add_f32 v[190:191], v[190:191], v[58:59]
    s_mov_b32 exec_hi, -1
    v_mov_b32 v4, v190
    v_mov_b32 v5, v190
    v_maximum3_f32 v6, |v180|, |v181|, |v182|
    v_maximum3_f32 v8, |v183|, |v184|, |v185|
    v_permlane32_swap_b32 v4, v5
    v_maximum3_f32 v6, v6, |v186|, |v187|
    v_maximum3_f32 v8, v8, |v188|, |v189|
    v_cmp_nle_f32 vcc, s59, v4
    v_cmp_nge_f32 s[76:77], s60, v4
    v_maximum3_f32 v6, v6, v8, v8
    s_or_b64 vcc, vcc, s[76:77]
    v_cmp_ngt_f32 s[76:77], s63, v6
    s_or_b64 vcc, vcc, s[76:77]
    s_cbranch_vccnz L_slow0
    v_rcp_f32 v4, v4
    s_nop 0
    v_mov_b32 v5, v4
    v_pk_mul_f32 v[180:181], v[180:181], v[4:5]
    v_pk_mul_f32 v[182:183], v[182:183], v[4:5]
    v_pk_mul_f32 v[184:185], v[184:185], v[4:5]
    v_pk_mul_f32 v[186:187], v[186:187], v[4:5]
    v_pk_mul_f32 v[188:189], v[188:189], v[4:5]
    v_cvt_pk_bf16_f32 v16, v180, v181
    v_cvt_pk_bf16_f32 v17, v182, v183
    v_cvt_pk_bf16_f32 v18, v184, v185
    v_cvt_pk_bf16_f32 v19, v186, v187
    v_cvt_pk_bf16_f32 v20, v188, v189
    s_branch L_fin
L_send0:
    ds_write_b128 v134, v[180:183]
    ds_write_b128 v134, v[184:187] offset:1024
    s_mov_b32 exec_hi, 0
    ds_write_b128 v134, v[188:191] offset:2048
    s_mov_b32 exec_hi, -1
    s_waitcnt vmcnt(0)
L_f21:
    v_xor_b32 v216, s72, v216
    v_xor_b32 v217, s73, v217
    v_or_b32 v2, v216, v217
    v_cmp_ne_u32 vcc, 0, v2
    s_cbranch_vccnz L_f2retry1
L_f2ok1:
    s_mov_b32 s66, 0
    s_waitcnt lgkmcnt(0)
    s_barrier
    ds_read_b128 v[48:51], v135 offset:0
    ds_read_b128 v[52:55], v135 offset:1024
    ds_read_b128 v[56:59], v135 offset:2048
    ds_read_b64_tr_b16 v[80:81], v136 offset:0
    ds_read_b64_tr_b16 v[82:83], v137 offset:0
    ds_read_b64_tr_b16 v[84:85], v136 offset:32
    ds_read_b64_tr_b16 v[86:87], v137 offset:32
    s_waitcnt lgkmcnt(5)
    v_pk_add_f32 v[196:197], v[196:197], v[48:49]
    v_pk_add_f32 v[198:199], v[198:199], v[50:51]
    v_pk_add_f32 v[200:201], v[200:201], v[52:53]
    v_pk_add_f32 v[202:203], v[202:203], v[54:55]
    s_waitcnt lgkmcnt(4)
    s_mov_b32 exec_hi, 0
    v_pk_add_f32 v[204:205], v[204:205], v[56:57]
    v_pk_add_f32 v[206:207], v[206:207], v[58:59]
    s_mov_b32 exec_hi, -1
    v_mov_b32 v4, v206
    v_mov_b32 v5, v206
    v_maximum3_f32 v6, |v196|, |v197|, |v198|
    v_maximum3_f32 v8, |v199|, |v200|, |v201|
    v_permlane32_swap_b32 v4, v5
    v_maximum3_f32 v6, v6, |v202|, |v203|
    v_maximum3_f32 v8, v8, |v204|, |v205|
    v_cmp_nle_f32 vcc, s59, v4
    v_cmp_nge_f32 s[76:77], s60, v4
    v_maximum3_f32 v6, v6, v8, v8
    s_or_b64 vcc, vcc, s[76:77]
    v_cmp_ngt_f32 s[76:77], s63, v6
    s_or_b64 vcc, vcc, s[76:77]
    s_cbranch_vccnz L_slow1
    v_rcp_f32 v4, v4
    s_nop 0
    v_mov_b32 v5, v4
    v_pk_mul_f32 v[196:197], v[196:197], v[4:5]
    v_pk_mul_f32 v[198:199], v[198:199], v[4:5]
    v_pk_mul_f32 v[200:201], v[200:201], v[4:5]
    v_pk_mul_f32 v[202:203], v[202:203], v[4:5]
    v_pk_mul_f32 v[204:205], v[204:205], v[4:5]
    v_cvt_pk_bf16_f32 v16, v196, v197
    v_cvt_pk_bf16_f32 v17, v198, v199
    v_cvt_pk_bf16_f32 v18, v200, v201
    v_cvt_pk_bf16_f32 v19, v202, v203
    v_cvt_pk_bf16_f32 v20, v204, v205
L_fin:
    s_cmp_eq_u32 s74, 15
    s_cbranch_scc1 L_ofast
    buffer_store_dwordx4 v[16:19], v15, s[36:39], s67 offen sc1
    s_mov_b32 exec_hi, 0
    buffer_store_dword v20, v15, s[36:39], s68 offen sc1
    s_mov_b32 exec_hi, -1
    s_branch L_odone
L_ofast:
    buffer_store_dwordx4 v[16:19], v15, s[36:39], s67 offen
    s_mov_b32 exec_hi, 0
    buffer_store_dword v20, v15, s[36:39], s68 offen
    s_mov_b32 exec_hi, -1
L_odone:
    ds_read_b64_tr_b16 v[88:89], v136 offset:64
    ds_read_b64_tr_b16 v[90:91], v137 offset:64
    ds_read_b64_tr_b16 v[92:93], v136 offset:96
    ds_read_b64_tr_b16 v[94:95], v137 offset:96
    ds_read_b64_tr_b16 v[96:97], v136 offset:128
    ds_read_b64_tr_b16 v[98:99], v137 offset:128
    ds_read_b64_tr_b16 v[100:101], v136 offset:11520
    ds_read_b64_tr_b16 v[102:103], v137 offset:11520
    ds_read_b64_tr_b16 v[104:105], v136 offset:11552
    ds_read_b64_tr_b16 v[106:107], v137 offset:11552
    ds_read_b64_tr_b16 v[108:109], v136 offset:11584
    ds_read_b64_tr_b16 v[110:111], v137 offset:11584
    s_add_u32 s60, s88, 0
    buffer_load_dwordx4 v[24:27], v142, s[36:39], s60 offen sc1
    s_add_u32 s60, s88, 4096
    buffer_load_dwordx4 v[32:35], v142, s[36:39], s60 offen sc1
    s_add_u32 s60, s88, 8192
    buffer_load_dwordx4 v[40:43], v142, s[36:39], s60 offen sc1
    ds_read_b64_tr_b16 v[112:113], v136 offset:11616
    ds_read_b64_tr_b16 v[114:115], v137 offset:11616
    ds_read_b64_tr_b16 v[116:117], v136 offset:11648
    ds_read_b64_tr_b16 v[118:119], v137 offset:11648
    ds_read_b64_tr_b16 v[220:221], v136 offset:23040
    ds_read_b64_tr_b16 v[222:223], v137 offset:23040
    ds_read_b64_tr_b16 v[224:225], v136 offset:23072
    ds_read_b64_tr_b16 v[226:227], v137 offset:23072
    ds_read_b64_tr_b16 v[228:229], v136 offset:23104
    ds_read_b64_tr_b16 v[230:231], v137 offset:23104
    ds_read_b64_tr_b16 v[232:233], v136 offset:23136
    ds_read_b64_tr_b16 v[234:235], v137 offset:23136
    ds_read_b64_tr_b16 v[236:237], v136 offset:23168
    ds_read_b64_tr_b16 v[238:239], v137 offset:23168
    ds_read_b64_tr_b16 v[240:241], v136 offset:34560
    ds_read_b64_tr_b16 v[242:243], v137 offset:34560
    ds_read_b64_tr_b16 v[244:245], v136 offset:34592
    ds_read_b64_tr_b16 v[246:247], v137 offset:34592
    ds_read_b64_tr_b16 v[248:249], v136 offset:34624
    ds_read_b64_tr_b16 v[250:251], v137 offset:34624
    ds_read_b64_tr_b16 v[252:253], v136 offset:34656
    ds_read_b64_tr_b16 v[254:255], v137 offset:34656
    ds_read_b64_tr_b16 v[148:149], v136 offset:34688
    ds_read_b64_tr_b16 v[150:151], v137 offset:34688
    ds_read_b64_tr_b16 v[152:153], v136 offset:5760
    ds_read_b64_tr_b16 v[154:155], v137 offset:5760
    ds_read_b64_tr_b16 v[156:157], v136 offset:5792
    ds_read_b64_tr_b16 v[158:159], v137 offset:5792
    ds_read_b64_tr_b16 v[160:161], v136 offset:5824
    ds_read_b64_tr_b16 v[162:163], v137 offset:5824
    ds_read_b64_tr_b16 v[164:165], v136 offset:5856
    ds_read_b64_tr_b16 v[166:167], v137 offset:5856
    ds_read_b64_tr_b16 v[168:169], v136 offset:5888
    ds_read_b64_tr_b16 v[170:171], v137 offset:5888
    ds_read_b64_tr_b16 v[172:173], v136 offset:17280
    ds_read_b64_tr_b16 v[174:175], v137 offset:17280
    ds_read_b64_tr_b16 v[180:181], v136 offset:17312
    ds_read_b64_tr_b16 v[182:183], v137 offset:17312
    ds_read_b64_tr_b16 v[184:185], v136 offset:17344
    ds_read_b64_tr_b16 v[186:187], v137 offset:17344
    ds_read_b64_tr_b16 v[188:189], v136 offset:17376
    ds_read_b64_tr_b16 v[190:191], v137 offset:17376
    ds_read_b64_tr_b16 v[192:193], v136 offset:17408
    ds_read_b64_tr_b16 v[194:195], v137 offset:17408
L_ochk0:
    s_waitcnt vmcnt(2)
    v_max3_u32 v2, v24, v25, v26
    v_max_u32 v2, v2, v27
    v_cmp_eq_u32 vcc, -1, v2
    s_cbranch_vccnz L_oretry0
L_ook0:
    s_add_u32 s60, s88, 12288
    buffer_load_dwordx4 v[48:51], v142, s[36:39], s60 offen sc1
    s_waitcnt lgkmcnt(0)
    v_mfma_f32_16x16x32_bf16 v[60:63], v[80:83], v[24:27], 0
    ds_read_b64_tr_b16 v[196:197], v136 offset:28800
    ds_read_b64_tr_b16 v[198:199], v137 offset:28800
    v_mfma_f32_16x16x32_bf16 v[64:67], v[84:87], v[24:27], 0
    ds_read_b64_tr_b16 v[80:81], v136 offset:28832
    ds_read_b64_tr_b16 v[82:83], v137 offset:28832
    v_mfma_f32_16x16x32_bf16 v[68:71], v[88:91], v[24:27], 0
    ds_read_b64_tr_b16 v[84:85], v136 offset:28864
    ds_read_b64_tr_b16 v[86:87], v137 offset:28864
    v_mfma_f32_16x16x32_bf16 v[72:75], v[92:95], v[24:27], 0
    ds_read_b64_tr_b16 v[88:89], v136 offset:28896
    ds_read_b64_tr_b16 v[90:91], v137 offset:28896
    v_mfma_f32_16x16x32_bf16 v[76:79], v[96:99], v[24:27], 0
    ds_read_b64_tr_b16 v[92:93], v136 offset:28928
    ds_read_b64_tr_b16 v[94:95], v137 offset:28928
L_ochk1:
    s_waitcnt vmcnt(2)
    v_max3_u32 v2, v32, v33, v34
    v_max_u32 v2, v2, v35
    v_cmp_eq_u32 vcc, -1, v2
    s_cbranch_vccnz L_oretry1
L_ook1:
    s_add_u32 s60, s88, 2048
    buffer_load_dwordx4 v[28:31], v142, s[36:39], s60 offen sc1
    v_mfma_f32_16x16x32_bf16 v[60:63], v[100:103], v[32:35], v[60:63]
    ds_read_b64_tr_b16 v[96:97], v136 offset:40320
    ds_read_b64_tr_b16 v[98:99], v137 offset:40320
    v_mfma_f32_16x16x32_bf16 v[64:67], v[104:107], v[32:35], v[64:67]
    ds_read_b64_tr_b16 v[100:101], v136 offset:40352
    ds_read_b64_tr_b16 v[102:103], v137 offset:40352
    v_mfma_f32_16x16x32_bf16 v[68:71], v[108:111], v[32:35], v[68:71]
    ds_read_b64_tr_b16 v[104:105], v136 offset:40384
    ds_read_b64_tr_b16 v[106:107], v137 offset:40384
    v_mfma_f32_16x16x32_bf16 v[72:75], v[112:115], v[32:35], v[72:75]
    ds_read_b64_tr_b16 v[108:109], v136 offset:40416
    ds_read_b64_tr_b16 v[110:111], v137 offset:40416
    v_mfma_f32_16x16x32_bf16 v[76:79], v[116:119], v[32:35], v[76:79]
    ds_read_b64_tr_b16 v[112:113], v136 offset:40448
    ds_read_b64_tr_b16 v[114:115], v137 offset:40448
L_ochk2:
    s_waitcnt vmcnt(2)
    v_max3_u32 v2, v40, v41, v42
    v_max_u32 v2, v2, v43
    v_cmp_eq_u32 vcc, -1, v2
    s_cbranch_vccnz L_oretry2
L_ook2:
    s_add_u32 s60, s88, 6144
    buffer_load_dwordx4 v[36:39], v142, s[36:39], s60 offen sc1
    v_mfma_f32_16x16x32_bf16 v[60:63], v[220:223], v[40:43], v[60:63]
    ds_read_b64_tr_b16 v[116:117], v138 offset:0
    ds_read_b64_tr_b16 v[118:119], v139 offset:0
    v_mfma_f32_16x16x32_bf16 v[64:67], v[224:227], v[40:43], v[64:67]
    ds_read_b64_tr_b16 v[220:221], v138 offset:32
    ds_read_b64_tr_b16 v[222:223], v139 offset:32
    v_mfma_f32_16x16x32_bf16 v[68:71], v[228:231], v[40:43], v[68:71]
    ds_read_b64_tr_b16 v[224:225], v138 offset:64
    ds_read_b64_tr_b16 v[226:227], v139 offset:64
    v_mfma_f32_16x16x32_bf16 v[72:75], v[232:235], v[40:43], v[72:75]
    ds_read_b64_tr_b16 v[228:229], v138 offset:96
    ds_read_b64_tr_b16 v[230:231], v139 offset:96
    v_mfma_f32_16x16x32_bf16 v[76:79], v[236:239], v[40:43], v[76:79]
    ds_read_b64_tr_b16 v[232:233], v138 offset:128
    ds_read_b64_tr_b16 v[234:235], v139 offset:128
L_ochk3:
    s_waitcnt vmcnt(2)
    v_max3_u32 v2, v48, v49, v50
    v_max_u32 v2, v2, v51
    v_cmp_eq_u32 vcc, -1, v2
    s_cbranch_vccnz L_oretry3
L_ook3:
    s_add_u32 s60, s88, 10240
    buffer_load_dwordx4 v[44:47], v142, s[36:39], s60 offen sc1
    v_mfma_f32_16x16x32_bf16 v[60:63], v[240:243], v[48:51], v[60:63]
    v_mfma_f32_16x16x32_bf16 v[64:67], v[244:247], v[48:51], v[64:67]
    v_mfma_f32_16x16x32_bf16 v[68:71], v[248:251], v[48:51], v[68:71]
    v_mfma_f32_16x16x32_bf16 v[72:75], v[252:255], v[48:51], v[72:75]
    v_mfma_f32_16x16x32_bf16 v[76:79], v[148:151], v[48:51], v[76:79]
L_ochk4:
    s_waitcnt vmcnt(2)
    v_max3_u32 v2, v28, v29, v30
    v_max_u32 v2, v2, v31
    v_cmp_eq_u32 vcc, -1, v2
    s_cbranch_vccnz L_oretry4
L_ook4:
    s_add_u32 s60, s88, 14336
    buffer_load_dwordx4 v[52:55], v142, s[36:39], s60 offen sc1
    v_mfma_f32_16x16x32_bf16 v[60:63], v[152:155], v[28:31], v[60:63]
    v_mfma_f32_16x16x32_bf16 v[64:67], v[156:159], v[28:31], v[64:67]
    v_mfma_f32_16x16x32_bf16 v[68:71], v[160:163], v[28:31], v[68:71]
    v_mfma_f32_16x16x32_bf16 v[72:75], v[164:167], v[28:31], v[72:75]
    v_mfma_f32_16x16x32_bf16 v[76:79], v[168:171], v[28:31], v[76:79]
L_ochk5:
    s_waitcnt vmcnt(2)
    v_max3_u32 v2, v36, v37, v38
    v_max_u32 v2, v2, v39
    v_cmp_eq_u32 vcc, -1, v2
    s_cbranch_vccnz L_oretry5
L_ook5:
    buffer_load_dwordx4 v[56:59], v143, s[36:39], s89 offen sc1
    v_mfma_f32_16x16x32_bf16 v[60:63], v[172:175], v[36:39], v[60:63]
    v_mfma_f32_16x16x32_bf16 v[64:67], v[180:183], v[36:39], v[64:67]
    v_mfma_f32_16x16x32_bf16 v[68:71], v[184:187], v[36:39], v[68:71]
    v_mfma_f32_16x16x32_bf16 v[72:75], v[188:191], v[36:39], v[72:75]
    v_mfma_f32_16x16x32_bf16 v[76:79], v[192:195], v[36:39], v[76:79]
L_ochk6:
    s_waitcnt vmcnt(2)
    v_max3_u32 v2, v44, v45, v46
    v_max_u32 v2, v2, v47
    v_cmp_eq_u32 vcc, -1, v2
    s_cbranch_vccnz L_oretry6
L_ook6:
    s_waitcnt lgkmcnt(15)
    v_mfma_f32_16x16x32_bf16 v[60:63], v[196:199], v[44:47], v[60:63]
    s_waitcnt lgkmcnt(15)
    v_mfma_f32_16x16x32_bf16 v[64:67], v[80:83], v[44:47], v[64:67]
    s_waitcnt lgkmcnt(15)
    v_mfma_f32_16x16x32_bf16 v[68:71], v[84:87], v[44:47], v[68:71]
    s_waitcnt lgkmcnt(15)
    v_mfma_f32_16x16x32_bf16 v[72:75], v[88:91], v[44:47], v[72:75]
    s_waitcnt lgkmcnt(15)
    v_mfma_f32_16x16x32_bf16 v[76:79], v[92:95], v[44:47], v[76:79]
L_ochk7:
    s_waitcnt vmcnt(1)
    v_max3_u32 v2, v52, v53, v54
    v_max_u32 v2, v2, v55
    v_cmp_eq_u32 vcc, -1, v2
    s_cbranch_vccnz L_oretry7
L_ook7:
    s_waitcnt lgkmcnt(15)
    v_mfma_f32_16x16x32_bf16 v[60:63], v[96:99], v[52:55], v[60:63]
    s_waitcnt lgkmcnt(15)
    v_mfma_f32_16x16x32_bf16 v[64:67], v[100:103], v[52:55], v[64:67]
    s_waitcnt lgkmcnt(14)
    v_mfma_f32_16x16x32_bf16 v[68:71], v[104:107], v[52:55], v[68:71]
    s_waitcnt lgkmcnt(12)
    v_mfma_f32_16x16x32_bf16 v[72:75], v[108:111], v[52:55], v[72:75]
    s_waitcnt lgkmcnt(10)
    v_mfma_f32_16x16x32_bf16 v[76:79], v[112:115], v[52:55], v[76:79]
L_ochk8:
    s_waitcnt vmcnt(0)
    v_max3_u32 v2, v56, v57, v58
    v_max_u32 v2, v2, v59
    v_cmp_eq_u32 vcc, -1, v2
    s_cbranch_vccnz L_oretry8
L_ook8:
    s_waitcnt lgkmcnt(8)
    v_mfma_f32_16x16x32_bf16 v[60:63], v[116:119], v[56:59], v[60:63]
    s_waitcnt lgkmcnt(6)
    v_mfma_f32_16x16x32_bf16 v[64:67], v[220:223], v[56:59], v[64:67]
    s_waitcnt lgkmcnt(4)
    v_mfma_f32_16x16x32_bf16 v[68:71], v[224:227], v[56:59], v[68:71]
    s_waitcnt lgkmcnt(2)
    v_mfma_f32_16x16x32_bf16 v[72:75], v[228:231], v[56:59], v[72:75]
    s_waitcnt lgkmcnt(0)
    v_mfma_f32_16x16x32_bf16 v[76:79], v[232:235], v[56:59], v[76:79]
    s_cmp_eq_u32 s91, 0
    s_cbranch_scc0 L_ofin1
    s_nop 5
    ds_write_b128 v140, v[68:71] offset:2048
    ds_write_b128 v140, v[72:75] offset:3072
    s_waitcnt lgkmcnt(0)
    s_barrier
    ds_read_b128 v[80:83], v140 offset:0
    ds_read_b128 v[84:87], v140 offset:1024
    ds_read_b128 v[96:99], v140 offset:4096
    s_waitcnt lgkmcnt(2)
    v_pk_add_f32 v[60:61], v[60:61], v[80:81]
    v_pk_add_f32 v[62:63], v[62:63], v[82:83]
    v_cvt_pk_bf16_f32 v16, v60, v61
    v_cvt_pk_bf16_f32 v17, v62, v63
    s_waitcnt lgkmcnt(1)
    v_pk_add_f32 v[64:65], v[64:65], v[84:85]
    v_pk_add_f32 v[66:67], v[66:67], v[86:87]
    v_cvt_pk_bf16_f32 v18, v64, v65
    v_cvt_pk_bf16_f32 v19, v66, v67
    s_waitcnt lgkmcnt(0)
    v_pk_add_f32 v[76:77], v[76:77], v[96:97]
    v_pk_add_f32 v[78:79], v[78:79], v[98:99]
    v_cvt_pk_bf16_f32 v20, v76, v77
    v_cvt_pk_bf16_f32 v21, v78, v79
    v_permlane16_swap_b32 v16, v18
    v_permlane16_swap_b32 v17, v19
    buffer_store_dwordx4 v[16:19], v219, s[44:47], s90 offen offset:0
    s_mov_b32 exec_hi, 0
    buffer_store_dwordx2 v[20:21], v141, s[44:47], s90 offen offset:128
    s_endpgm
L_ofin1:
    s_nop 5
    ds_write_b128 v140, v[60:63] offset:0
    ds_write_b128 v140, v[64:67] offset:1024
    ds_write_b128 v140, v[76:79] offset:4096
    s_waitcnt lgkmcnt(0)
    s_barrier
    ds_read_b128 v[88:91], v140 offset:2048
    ds_read_b128 v[92:95], v140 offset:3072
    s_waitcnt lgkmcnt(1)
    v_pk_add_f32 v[68:69], v[68:69], v[88:89]
    v_pk_add_f32 v[70:71], v[70:71], v[90:91]
    v_cvt_pk_bf16_f32 v16, v68, v69
    v_cvt_pk_bf16_f32 v17, v70, v71
    s_waitcnt lgkmcnt(0)
    v_pk_add_f32 v[72:73], v[72:73], v[92:93]
    v_pk_add_f32 v[74:75], v[74:75], v[94:95]
    v_cvt_pk_bf16_f32 v18, v72, v73
    v_cvt_pk_bf16_f32 v19, v74, v75
    s_nop 1
    v_permlane16_swap_b32 v16, v18
    v_permlane16_swap_b32 v17, v19
    buffer_store_dwordx4 v[16:19], v219, s[44:47], s90 offen offset:64
L_end:
    s_endpgm
L_oretry0:
    s_add_u32 s66, s66, 1
    s_cmp_gt_u32 s66, 131072
    s_cbranch_scc1 L_ook0
    s_waitcnt vmcnt(0)
    s_add_u32 s60, s88, 0
    buffer_load_dwordx4 v[24:27], v142, s[36:39], s60 offen sc1
    s_add_u32 s60, s88, 4096
    buffer_load_dwordx4 v[32:35], v142, s[36:39], s60 offen sc1
    s_add_u32 s60, s88, 8192
    buffer_load_dwordx4 v[40:43], v142, s[36:39], s60 offen sc1
    s_branch L_ochk0
L_oretry1:
    s_add_u32 s66, s66, 1
    s_cmp_gt_u32 s66, 131072
    s_cbranch_scc1 L_ook1
    s_waitcnt vmcnt(0)
    s_add_u32 s60, s88, 4096
    buffer_load_dwordx4 v[32:35], v142, s[36:39], s60 offen sc1
    s_add_u32 s60, s88, 8192
    buffer_load_dwordx4 v[40:43], v142, s[36:39], s60 offen sc1
    s_add_u32 s60, s88, 12288
    buffer_load_dwordx4 v[48:51], v142, s[36:39], s60 offen sc1
    s_branch L_ochk1
L_oretry2:
    s_add_u32 s66, s66, 1
    s_cmp_gt_u32 s66, 131072
    s_cbranch_scc1 L_ook2
    s_waitcnt vmcnt(0)
    s_add_u32 s60, s88, 8192
    buffer_load_dwordx4 v[40:43], v142, s[36:39], s60 offen sc1
    s_add_u32 s60, s88, 12288
    buffer_load_dwordx4 v[48:51], v142, s[36:39], s60 offen sc1
    s_add_u32 s60, s88, 2048
    buffer_load_dwordx4 v[28:31], v142, s[36:39], s60 offen sc1
    s_branch L_ochk2
L_oretry3:
    s_add_u32 s66, s66, 1
    s_cmp_gt_u32 s66, 131072
    s_cbranch_scc1 L_ook3
    s_waitcnt vmcnt(0)
    s_add_u32 s60, s88, 12288
    buffer_load_dwordx4 v[48:51], v142, s[36:39], s60 offen sc1
    s_add_u32 s60, s88, 2048
    buffer_load_dwordx4 v[28:31], v142, s[36:39], s60 offen sc1
    s_add_u32 s60, s88, 6144
    buffer_load_dwordx4 v[36:39], v142, s[36:39], s60 offen sc1
    s_branch L_ochk3
L_oretry4:
    s_add_u32 s66, s66, 1
    s_cmp_gt_u32 s66, 131072
    s_cbranch_scc1 L_ook4
    s_waitcnt vmcnt(0)
    s_add_u32 s60, s88, 2048
    buffer_load_dwordx4 v[28:31], v142, s[36:39], s60 offen sc1
    s_add_u32 s60, s88, 6144
    buffer_load_dwordx4 v[36:39], v142, s[36:39], s60 offen sc1
    s_add_u32 s60, s88, 10240
    buffer_load_dwordx4 v[44:47], v142, s[36:39], s60 offen sc1
    s_branch L_ochk4
L_oretry5:
    s_add_u32 s66, s66, 1
    s_cmp_gt_u32 s66, 131072
    s_cbranch_scc1 L_ook5
    s_waitcnt vmcnt(0)
    s_add_u32 s60, s88, 6144
    buffer_load_dwordx4 v[36:39], v142, s[36:39], s60 offen sc1
    s_add_u32 s60, s88, 10240
    buffer_load_dwordx4 v[44:47], v142, s[36:39], s60 offen sc1
    s_add_u32 s60, s88, 14336
    buffer_load_dwordx4 v[52:55], v142, s[36:39], s60 offen sc1
    s_branch L_ochk5
L_oretry6:
    s_add_u32 s66, s66, 1
    s_cmp_gt_u32 s66, 131072
    s_cbranch_scc1 L_ook6
    s_waitcnt vmcnt(0)
    s_add_u32 s60, s88, 10240
    buffer_load_dwordx4 v[44:47], v142, s[36:39], s60 offen sc1
    s_add_u32 s60, s88, 14336
    buffer_load_dwordx4 v[52:55], v142, s[36:39], s60 offen sc1
    buffer_load_dwordx4 v[56:59], v143, s[36:39], s89 offen sc1
    s_branch L_ochk6
L_oretry7:
    s_add_u32 s66, s66, 1
    s_cmp_gt_u32 s66, 131072
    s_cbranch_scc1 L_ook7
    s_waitcnt vmcnt(0)
    s_add_u32 s60, s88, 14336
    buffer_load_dwordx4 v[52:55], v142, s[36:39], s60 offen sc1
    buffer_load_dwordx4 v[56:59], v143, s[36:39], s89 offen sc1
    s_branch L_ochk7
L_oretry8:
    s_add_u32 s66, s66, 1
    s_cmp_gt_u32 s66, 131072
    s_cbranch_scc1 L_ook8
    s_waitcnt vmcnt(0)
    buffer_load_dwordx4 v[56:59], v143, s[36:39], s89 offen sc1
    s_branch L_ochk8
L_f2retry0:
    s_add_u32 s66, s66, 1
    s_cmp_gt_u32 s66, 131072
    s_cbranch_scc1 L_f2ok0
    s_sleep 2
    buffer_load_dwordx2 v[216:217], v178, s[32:35], s84 offen sc1
    s_waitcnt vmcnt(0)
    s_branch L_f20
L_f2retry1:
    s_add_u32 s66, s66, 1
    s_cmp_gt_u32 s66, 131072
    s_cbranch_scc1 L_f2ok1
    s_sleep 2
    buffer_load_dwordx2 v[216:217], v178, s[32:35], s84 offen sc1
    s_waitcnt vmcnt(0)
    s_branch L_f21
L_slow1:
    v_mov_b32 v32, v40
    v_mov_b32 v33, v41
    v_mov_b32 v34, v42
    v_mov_b32 v35, v43
L_slow0:
    s_waitcnt lgkmcnt(0)
    s_add_u32 s59, s87, 56832
    v_subrev_u32 v124, s59, v124
    v_subrev_u32 v125, s59, v125
    v_subrev_u32 v126, s59, v126
    v_mov_b32 v36, v46
    v_mov_b32 v37, 0
    s_cmp_eq_u32 s58, 1
    s_cselect_b64 vcc, -1, 0
    v_permlane32_swap_b32 v36, v46
    s_nop 1
    v_cndmask_b32 v36, v36, v46, vcc
    s_mov_b32 exec_lo, 0
    v_mov_b32 v36, 0
    s_mov_b32 exec_lo, -1
    v_mov_b32 v9, 0xff800000
    v_mov_b32 v180, 0
    v_mov_b32 v181, 0
    v_mov_b32 v182, 0
    v_mov_b32 v183, 0
    v_mov_b32 v184, 0
    v_mov_b32 v185, 0
    v_mov_b32 v186, 0
    v_mov_b32 v187, 0
    v_mov_b32 v188, 0
    v_mov_b32 v189, 0
    v_mov_b32 v190, 0
    v_mov_b32 v191, 0
    v_mov_b32 v192, 0
    v_mov_b32 v193, 0
    v_mov_b32 v194, 0
    v_mov_b32 v195, 0
    s_mov_b32 s60, 0
L_sloop:
    buffer_load_dwordx4 v[156:159], v124, s[32:35], s60 offen sc1
    buffer_load_dword v160, v126, s[32:35], s60 offen offset:2240 sc1
    buffer_load_dwordx4 v[152:155], v125, s[32:35], s60 offen offset:1024 sc1
    buffer_load_dwordx4 v[148:151], v125, s[32:35], s60 offen offset:1632 sc1
    s_waitcnt vmcnt(0)
    v_mfma_f32_32x32x16_bf16 v[48:63], v[156:159], v[32:35], 0
    v_mfma_f32_32x32x8_bf16 v[48:63], v[160:161], v[36:37], v[48:63]
    s_nop 11
    v_max3_f32 v4, v48, v49, v50
    v_max3_f32 v4, v4, v51, v52
    v_max3_f32 v4, v4, v53, v54
    v_max3_f32 v4, v4, v55, v56
    v_max3_f32 v4, v4, v57, v58
    v_max3_f32 v4, v4, v59, v60
    v_max3_f32 v4, v4, v61, v62
    v_max_f32 v4, v4, v63
    v_mov_b32 v5, v4
    s_nop 1
    v_permlane32_swap_b32 v4, v5
    s_nop 0
    v_max_f32 v4, v4, v5
    v_max_f32 v4, v4, v9
    v_sub_f32 v5, v9, v4
    v_exp_f32 v5, v5
    v_mov_b32 v9, v4
    v_mul_f32 v180, v180, v5
    v_mul_f32 v181, v181, v5
    v_mul_f32 v182, v182, v5
    v_mul_f32 v183, v183, v5
    v_mul_f32 v184, v184, v5
    v_mul_f32 v185, v185, v5
    v_mul_f32 v186, v186, v5
    v_mul_f32 v187, v187, v5
    v_mul_f32 v188, v188, v5
    v_mul_f32 v189, v189, v5
    v_mul_f32 v190, v190, v5
    v_mul_f32 v191, v191, v5
    v_mul_f32 v192, v192, v5
    v_mul_f32 v193, v193, v5
    v_mul_f32 v194, v194, v5
    v_mul_f32 v195, v195, v5
    v_sub_f32 v48, v48, v4
    v_sub_f32 v49, v49, v4
    v_sub_f32 v50, v50, v4
    v_sub_f32 v51, v51, v4
    v_sub_f32 v52, v52, v4
    v_sub_f32 v53, v53, v4
    v_sub_f32 v54, v54, v4
    v_sub_f32 v55, v55, v4
    v_sub_f32 v56, v56, v4
    v_sub_f32 v57, v57, v4
    v_sub_f32 v58, v58, v4
    v_sub_f32 v59, v59, v4
    v_sub_f32 v60, v60, v4
    v_sub_f32 v61, v61, v4
    v_sub_f32 v62, v62, v4
    v_sub_f32 v63, v63, v4
    v_exp_f32 v48, v48
    v_exp_f32 v49, v49
    v_exp_f32 v50, v50
    v_exp_f32 v51, v51
    v_exp_f32 v52, v52
    v_exp_f32 v53, v53
    v_exp_f32 v54, v54
    v_exp_f32 v55, v55
    v_exp_f32 v56, v56
    v_exp_f32 v57, v57
    v_exp_f32 v58, v58
    v_exp_f32 v59, v59
    v_exp_f32 v60, v60
    v_exp_f32 v61, v61
    v_exp_f32 v62, v62
    v_exp_f32 v63, v63
    s_nop 1
    v_smfmac_f32_32x32x32_bf16 v[180:195], v[152:155], v[48:55], v127
    v_smfmac_f32_32x32x32_bf16 v[180:195], v[148:151], v[56:63], v127
    s_add_u32 s60, s60, 2368
    s_cmp_lt_u32 s60, 151552
    s_cbranch_scc1 L_sloop
    s_nop 11
    v_mov_b32 v4, v190
    v_mov_b32 v5, v190
    s_nop 1
    v_permlane32_swap_b32 v4, v5
    s_mov_b32 s59, 0xfffffffe
    v_rcp_f32 v4, v4
    s_nop 0
    v_mov_b32 v5, v4
    v_pk_mul_f32 v[180:181], v[180:181], v[4:5]
    v_pk_mul_f32 v[182:183], v[182:183], v[4:5]
    v_pk_mul_f32 v[184:185], v[184:185], v[4:5]
    v_pk_mul_f32 v[186:187], v[186:187], v[4:5]
    v_pk_mul_f32 v[188:189], v[188:189], v[4:5]
    v_cvt_pk_bf16_f32 v16, v180, v181
    v_cvt_pk_bf16_f32 v17, v182, v183
    v_cvt_pk_bf16_f32 v18, v184, v185
    v_cvt_pk_bf16_f32 v19, v186, v187
    v_cvt_pk_bf16_f32 v20, v188, v189
    v_min_u32 v16, s59, v16
    v_min_u32 v17, s59, v17
    v_min_u32 v18, s59, v18
    v_min_u32 v19, s59, v19
    v_min_u32 v20, s59, v20
    s_branch L_fin
L_codeend:
.section .rodata,"a"
.p2align 6
.amdhsa_kernel standalone__grouped_kv_mqa__prompt_kernel
  .amdhsa_next_free_vgpr 256
  .amdhsa_next_free_sgpr 102
  .amdhsa_accum_offset 256
  .amdhsa_group_segment_fixed_size 0
  .amdhsa_kernarg_size 64
  .amdhsa_user_sgpr_count 2
  .amdhsa_user_sgpr_kernarg_segment_ptr 1
  .amdhsa_system_sgpr_workgroup_id_x 1
.end_amdhsa_kernel
```
